```python
import torch

def _softmax(x, axis=-1):
    return torch.softmax(x, dim=axis)
def _gelu(x):
    return torch.nn.functional.gelu(x, approximate="tanh")
def _silu(x):
    return torch.nn.functional.silu(x)
def _sigmoid(x):
    return torch.sigmoid(x)
def _layernorm(x, axis=-1, eps=1e-5):
    m = x.mean(dim=axis, keepdim=True)
    v = x.var(dim=axis, keepdim=True, unbiased=False)
    return (x - m) / torch.sqrt(v + eps)
def _scatter_add(tgt, idx, src, axis=0):
    return tgt.clone().index_add_(axis, idx, src)
def _segment_sum(src, seg, n):
    out = torch.zeros((n,) + src.shape[1:], dtype=src.dtype)
    return out.index_add_(0, seg, src)
def _pad(x, pw):
    flat = tuple(v for pair in reversed(pw) for v in pair)
    return torch.nn.functional.pad(x, flat)

kernel_name = 'recurrent_scan__ssm_conv_s4d__dense_activation_gelu__prompt'

def setup_inputs():

    _w = (lambda a: (lambda t: t.to(torch.bfloat16) if t.is_floating_point() else t)(torch.as_tensor(a)))
    def _A_setup():
        Bsz, L, D, N = 1, 2048, 640, 128
        return {
            "u": _w((lambda *s: torch.randn(*s, dtype=torch.bfloat16) * 0.05)(Bsz, L, D)),
            "log_A_real": _w((lambda *s: torch.randn(*s, dtype=torch.bfloat16) * 6.4)(D, N) * 0.5),
            "A_imag": _w((lambda *s: torch.randn(*s, dtype=torch.bfloat16) * 0.2)(D, N) * 3.14),
            "C_real": _w((lambda *s: torch.randn(*s, dtype=torch.bfloat16) * 0.4)(D, N) / N ** 0.5),
            "C_imag": _w((lambda *s: torch.randn(*s, dtype=torch.bfloat16) * 0.4)(D, N) / N ** 0.5),
            "log_dt": _w((lambda *s: torch.randn(*s, dtype=torch.bfloat16) * 0.2)(D) * 0.5 - 4.0),
            "D_skip": _w((lambda *s: torch.randn(*s, dtype=torch.bfloat16) * 0.2)(D)),
        }
    _A_in = _A_setup()

    def _B_setup():
        B, S, D, F = 1, 2048, 640, 1728
        return {
            "x": _w((lambda *s: torch.randn(*s, dtype=torch.bfloat16) * 0.05)(B, S, D)),
            "w1": _w((lambda *s: torch.randn(*s, dtype=torch.bfloat16) * 0.8)(D, F) * (D ** -0.5)),
            "b1": _w((lambda *s: torch.randn(*s, dtype=torch.bfloat16) * 0.1)(F) * 0.01),
            "w2": _w((lambda *s: torch.randn(*s, dtype=torch.bfloat16) * 0.1)(F, D) * (F ** -0.5)),
            "b2": _w((lambda *s: torch.randn(*s, dtype=torch.bfloat16) * 0.1)(D) * 0.01),
        }
    _B_in = _B_setup()

    return {
        "A_u": _A_in["u"],
        "A_log_A_real": _A_in["log_A_real"],
        "A_A_imag": _A_in["A_imag"],
        "A_C_real": _A_in["C_real"],
        "A_C_imag": _A_in["C_imag"],
        "A_log_dt": _A_in["log_dt"],
        "A_D_skip": _A_in["D_skip"],
        "B_x": _B_in["x"],
        "B_w1": _B_in["w1"],
        "B_b1": _B_in["b1"],
        "B_w2": _B_in["w2"],
        "B_b2": _B_in["b2"],
    }

def reference(A_u, A_log_A_real, A_A_imag, A_C_real, A_C_imag, A_log_dt, A_D_skip, B_x, B_w1, B_b1, B_w2, B_b2):
    def _A_ref(u, log_A_real, A_imag, C_real, C_imag, log_dt, D_skip):
        L = u.shape[1]
        dt = torch.exp(log_dt)
        A = -torch.exp(log_A_real) + 1j * A_imag
        C = (C_real + 1j * C_imag) * dt[:, None]
        pos = (lambda x, dt: x.to(dt))(torch.arange(L), log_dt.dtype)
        P = torch.exp((A * dt[:, None])[:, :, None] * pos[None, None, :])
        K = 2.0 * torch.einsum("dn,dnl->dl", C, P).real
        L2 = 2 * L
        u_t = (lambda x, *d: x.permute(*d))(u, 0, 2, 1)
        Kf = (lambda x, *a, **k: torch.fft.rfft(x.float(), *a, **k))(K, L2)
        Uf = (lambda x, *a, **k: torch.fft.rfft(x.float(), *a, **k))(u_t, L2)
        y = (lambda x, *a, **k: torch.fft.irfft(x, *a, **k).to(torch.bfloat16))(Uf * Kf[None, :, :], L2)[:, :, :L]
        y = (lambda x, *d: x.permute(*d))(y, 0, 2, 1)
        return y + u * D_skip[None, None, :]

    def _B_ref(x, w1, b1, w2, b2):
        h = torch.einsum("bsd,df->bsf", x, w1) + b1
        h = _gelu(h)
        return torch.einsum("bsf,fd->bsd", h, w2) + b2

    x = A_u
    xn = _layernorm(x, axis=-1)
    s = _A_ref(xn, A_log_A_real, A_A_imag, A_C_real, A_C_imag, A_log_dt, A_D_skip)
    g = _silu(_B_ref(xn, B_w1, B_b1, B_w2, B_b2))
    return x + s * g
```

```asm
; @launch grid=(256,1,1) block=(512,1,1) lds=163840
.amdgcn_target "amdgcn-amd-amdhsa--gfx950"
.text
.globl recurrent_scan__ssm_conv_s4d__dense_activation_gelu__prompt_kernel
.p2align 8
.type recurrent_scan__ssm_conv_s4d__dense_activation_gelu__prompt_kernel,@function
recurrent_scan__ssm_conv_s4d__dense_activation_gelu__prompt_kernel:
    s_cmp_ge_u32 s2, 256
    s_cbranch_scc1 k_exit
    s_load_dwordx16 s[64:79], s[0:1], 0
    s_load_dwordx8 s[80:87], s[0:1], 64
    s_load_dwordx4 s[88:91], s[0:1], 96
    s_load_dwordx2 s[92:93], s[0:1], 112
    v_lshrrev_b32 v2, 6, v0
    v_and_b32 v1, 63, v0
    v_readfirstlane_b32 s28, v2
    s_and_b32 s44, s2, 7
    s_lshr_b32 s45, s2, 3
    s_mul_i32 s43, s44, 28
    s_add_u32 s43, s43, s45
    s_mul_i32 s46, s43, 3
    s_lshl_b32 s30, s43, 1
    s_add_u32 s30, s30, 192
    s_cmp_lt_u32 s43, 192
    s_cselect_b32 s46, s46, s30
    s_cselect_b32 s47, 3, 2
    s_cmp_ge_u32 s45, 28
    s_cselect_b32 s47, 0, s47
    s_and_b32 s30, s28, 3
    s_add_u32 s46, s46, s30
    s_cmp_lt_u32 s30, s47
    s_cselect_b32 s47, 1, 0
    s_cselect_b32 s46, s46, 0
    s_and_b32 s30, s46, 0xfffffffe
    s_lshl_b32 s30, s30, 1
    s_waitcnt lgkmcnt(0)
    s_load_dword s48, s[74:75], s30
    s_load_dword s49, s[76:77], s30
    s_mov_b32 s8, s64
    s_and_b32 s9, s65, 0xffff
    s_mov_b32 s10, 2621440
    s_mov_b32 s11, 0x00020000
    s_mov_b32 s12, s80
    s_and_b32 s13, s81, 0xffff
    s_mov_b32 s14, 2211840
    s_mov_b32 s15, 0x00020000
    s_mov_b32 s16, s92
    s_and_b32 s17, s93, 0xffff
    s_mov_b32 s18, 16777216
    s_mov_b32 s19, 0x00020000
    s_mov_b32 s20, s82
    s_and_b32 s21, s83, 0xffff
    s_mov_b32 s22, 3456
    s_mov_b32 s23, 0x00020000
    s_cmp_lg_u32 s2, 0
    s_cbranch_scc1 no_nonce
    s_mov_b32 s4, s90
    s_and_b32 s5, s91, 0xffff
    s_mov_b32 s6, 256
    s_mov_b32 s7, 0x00020000
    s_memrealtime s[62:63]
    v_mov_b32 v2, 0
    s_waitcnt lgkmcnt(0)
    s_or_b32 s62, s62, 1
    v_mov_b32 v3, s62
    v_cmp_eq_u32 vcc, 0, v0
    s_nop 3
    s_and_saveexec_b64 s[62:63], vcc
    s_cbranch_execz nonce_sent
    buffer_store_dword v3, v2, s[4:7], 0 offen sc1
nonce_sent:
    s_mov_b64 exec, s[62:63]
no_nonce:
    s_cmp_ge_u32 s45, 28
    s_cbranch_scc1 aux_role
    s_mul_i32 s30, s45, 37
    s_lshr_b32 s30, s30, 8
    s_mul_i32 s31, s30, 7
    s_sub_u32 s41, s45, s31
    s_lshr_b32 s31, s44, 1
    s_lshl_b32 s31, s31, 2
    s_add_u32 s42, s31, s30
    s_and_b32 s31, s44, 1
    s_mul_i32 s31, s31, 7
    s_add_u32 s41, s41, s31
    s_cmp_ge_u32 s28, 4
    s_cbranch_scc1 g1_loader
    s_setprio 3
    s_lshl_b32 s31, s46, 8
    v_lshlrev_b32 v16, 2, v1
    s_mov_b32 s4, s66
    s_and_b32 s5, s67, 0xffff
    s_mov_b32 s6, 163840
    s_mov_b32 s7, 0x00020000
    buffer_load_dword v10, v16, s[4:7], s31 offen
    s_mov_b32 s4, s68
    s_and_b32 s5, s69, 0xffff
    s_mov_b32 s6, 163840
    s_mov_b32 s7, 0x00020000
    buffer_load_dword v11, v16, s[4:7], s31 offen
    s_mov_b32 s4, s70
    s_and_b32 s5, s71, 0xffff
    s_mov_b32 s6, 163840
    s_mov_b32 s7, 0x00020000
    buffer_load_dword v12, v16, s[4:7], s31 offen
    s_mov_b32 s4, s72
    s_and_b32 s5, s73, 0xffff
    s_mov_b32 s6, 163840
    s_mov_b32 s7, 0x00020000
    buffer_load_dword v13, v16, s[4:7], s31 offen
    s_mov_b32 s4, s90
    s_and_b32 s5, s91, 0xffff
    s_mov_b32 s6, 256
    s_mov_b32 s7, 0x00020000
    v_mov_b32 v141, 0
    buffer_load_dword v140, v141, s[4:7], 0 offen sc1
    s_mul_i32 s30, s43, 205
    s_lshr_b32 s30, s30, 10
    s_mul_i32 s31, s30, 5
    s_sub_u32 s31, s43, s31
    s_mov_b32 s50, s30
    s_lshl_b32 s51, s31, 2
    s_and_b32 s30, s28, 3
    s_add_u32 s51, s51, s30
    s_lshl_b32 s55, s28, 11
    s_add_u32 s55, s55, 146688
    s_mov_b32 s4, s84
    s_and_b32 s5, s85, 0xffff
    s_mov_b32 s6, 2211840
    s_mov_b32 s7, 0x00020000
    v_lshrrev_b32 v230, 2, v1
    v_mul_u32_u24 v230, 1280, v230
    v_and_b32 v231, 3, v1
    v_lshl_add_u32 v230, v231, 4, v230
    s_mul_i32 s30, s50, 40960
    s_lshl_b32 s31, s51, 6
    s_add_u32 s30, s30, s31
    s_add_u32 s31, s30, 20480
    buffer_load_dwordx4 v[232:235], v230, s[4:7], s30 offen
    buffer_load_dwordx4 v[236:239], v230, s[4:7], s31 offen
    s_waitcnt lgkmcnt(0)
    s_bitcmp1_b32 s46, 0
    s_cbranch_scc1 ch_odd1
    s_lshl_b32 s48, s48, 16
    s_lshl_b32 s49, s49, 16
ch_odd1:
    s_and_b32 s48, s48, 0xffff0000
    s_and_b32 s49, s49, 0xffff0000
    s_waitcnt vmcnt(3)
    s_cmp_eq_u32 s47, 0
    s_cbranch_scc1 kgen_skip
    v_mov_b32 v3, s48
    v_mul_f32 v3, 0x3fb8aa3b, v3
    v_exp_f32 v3, v3
    s_nop 0
    v_cvt_pk_bf16_f32 v3, v3, v3
    v_lshlrev_b32 v3, 16, v3
    v_add_f32 v4, v3, v3
    v_readfirstlane_b32 s24, v3
    v_readfirstlane_b32 s25, v4
    s_and_b32 s30, s28, 3
    s_mul_i32 s30, s30, 16128
    s_add_u32 s30, s30, 98304
    v_mov_b32 v2, s30
    v_lshl_add_u32 v4, v1, 2, v2
    v_and_b32 v5, 15, v1
    v_mul_u32_u24 v5, 272, v5
    v_lshrrev_b32 v6, 4, v1
    v_lshl_add_u32 v5, v6, 4, v5
    v_add_u32 v5, v5, v2
    v_lshlrev_b32 v50, 16, v10
    v_lshlrev_b32 v51, 16, v11
    v_lshlrev_b32 v32, 16, v12
    v_lshlrev_b32 v33, 16, v13
    v_mul_f32 v50, 0x3fb8aa3b, v50
    v_exp_f32 v50, v50
    v_mul_f32 v51, s24, v51
    v_cvt_pk_bf16_f32 v50, v50, v50
    v_mul_f32 v51, 0x3e22f983, v51
    v_lshlrev_b32 v50, 16, v50
    v_mul_f32 v50, s24, v50
    v_mul_f32 v32, s25, v32
    v_mul_f32 v50, 0xbfb8aa3b, v50
    v_mul_f32_e64 v33, -v33, s25
    v_mul_f32 v52, 0x3f800000, v50
    v_mul_f32 v53, 0x3f800000, v51
    v_exp_f32 v52, v52
    v_fract_f32 v53, v53
    v_cos_f32 v54, v53
    v_sin_f32 v55, v53
    v_mul_f32 v20, v52, v54
    v_mul_f32_e64 v21, -v52, v55
    v_mul_f32 v52, 0x41000000, v50
    v_mul_f32 v53, 0x41000000, v51
    v_exp_f32 v52, v52
    v_fract_f32 v53, v53
    v_cos_f32 v54, v53
    v_sin_f32 v55, v53
    v_mul_f32 v28, v52, v54
    v_mul_f32 v29, v52, v55
    v_mul_f32 v52, 0x43000000, v50
    v_mul_f32 v53, 0x43000000, v51
    v_exp_f32 v52, v52
    v_fract_f32 v53, v53
    v_cos_f32 v54, v53
    v_sin_f32 v55, v53
    v_mul_f32 v26, v52, v54
    v_mul_f32_e64 v27, -v52, v55
    v_pk_mul_f32 v[30:31], v[20:21], v[20:21] op_sel:[1,1] op_sel_hi:[1,0] neg_lo:[1,0]
    v_pk_fma_f32 v[22:23], v[20:21], v[20:21], v[30:31] op_sel:[0,0,0] op_sel_hi:[0,1,1]
    v_pk_mul_f32 v[30:31], v[22:23], v[22:23] op_sel:[1,1] op_sel_hi:[1,0] neg_lo:[1,0]
    v_pk_fma_f32 v[24:25], v[22:23], v[22:23], v[30:31] op_sel:[0,0,0] op_sel_hi:[0,1,1]
    v_mov_b32 v48, 1.0
    v_mov_b32 v49, 0
    v_cvt_pk_bf16_f32 v56, v32, v33
    ds_write_b32 v4, v56 offset:0
    v_pk_mul_f32 v[30:31], v[32:33], v[20:21] op_sel:[1,1] op_sel_hi:[1,0] neg_lo:[1,0]
    v_pk_fma_f32 v[34:35], v[32:33], v[20:21], v[30:31] op_sel:[0,0,0] op_sel_hi:[0,1,1]
    v_cvt_pk_bf16_f32 v57, v34, v35
    ds_write_b32 v4, v57 offset:272
    v_pk_mul_f32 v[30:31], v[34:35], v[20:21] op_sel:[1,1] op_sel_hi:[1,0] neg_lo:[1,0]
    v_pk_fma_f32 v[36:37], v[34:35], v[20:21], v[30:31] op_sel:[0,0,0] op_sel_hi:[0,1,1]
    v_cvt_pk_bf16_f32 v58, v36, v37
    ds_write_b32 v4, v58 offset:544
    v_cvt_pk_bf16_f32 v59, v48, v49
    ds_write_b32 v4, v59 offset:11152
    v_cvt_pk_bf16_f32 v56, v28, v29
    ds_write_b32 v4, v56 offset:11424
    v_pk_mul_f32 v[30:31], v[36:37], v[20:21] op_sel:[1,1] op_sel_hi:[1,0] neg_lo:[1,0]
    v_pk_fma_f32 v[38:39], v[36:37], v[20:21], v[30:31] op_sel:[0,0,0] op_sel_hi:[0,1,1]
    v_cvt_pk_bf16_f32 v57, v38, v39
    ds_write_b32 v4, v57 offset:816
    v_pk_mul_f32 v[30:31], v[38:39], v[20:21] op_sel:[1,1] op_sel_hi:[1,0] neg_lo:[1,0]
    v_pk_fma_f32 v[40:41], v[38:39], v[20:21], v[30:31] op_sel:[0,0,0] op_sel_hi:[0,1,1]
    v_cvt_pk_bf16_f32 v58, v40, v41
    ds_write_b32 v4, v58 offset:1088
    v_pk_mul_f32 v[30:31], v[40:41], v[20:21] op_sel:[1,1] op_sel_hi:[1,0] neg_lo:[1,0]
    v_pk_fma_f32 v[42:43], v[40:41], v[20:21], v[30:31] op_sel:[0,0,0] op_sel_hi:[0,1,1]
    v_pk_mul_f32 v[52:53], v[28:29], v[28:29] op_sel:[1,1] op_sel_hi:[1,0] neg_lo:[1,0]
    v_pk_fma_f32 v[48:49], v[28:29], v[28:29], v[52:53] op_sel:[0,0,0] op_sel_hi:[0,1,1]
    v_cvt_pk_bf16_f32 v59, v48, v49
    ds_write_b32 v4, v59 offset:11696
    v_cvt_pk_bf16_f32 v56, v42, v43
    ds_write_b32 v4, v56 offset:1360
    v_pk_mul_f32 v[30:31], v[42:43], v[20:21] op_sel:[1,1] op_sel_hi:[1,0] neg_lo:[1,0]
    v_pk_fma_f32 v[44:45], v[42:43], v[20:21], v[30:31] op_sel:[0,0,0] op_sel_hi:[0,1,1]
    v_cvt_pk_bf16_f32 v57, v44, v45
    ds_write_b32 v4, v57 offset:1632
    v_pk_mul_f32 v[30:31], v[44:45], v[20:21] op_sel:[1,1] op_sel_hi:[1,0] neg_lo:[1,0]
    v_pk_fma_f32 v[46:47], v[44:45], v[20:21], v[30:31] op_sel:[0,0,0] op_sel_hi:[0,1,1]
    v_cvt_pk_bf16_f32 v58, v46, v47
    ds_write_b32 v4, v58 offset:1904
    v_pk_mul_f32 v[52:53], v[48:49], v[28:29] op_sel:[1,1] op_sel_hi:[1,0] neg_lo:[1,0]
    v_pk_fma_f32 v[48:49], v[48:49], v[28:29], v[52:53] op_sel:[0,0,0] op_sel_hi:[0,1,1]
    v_cvt_pk_bf16_f32 v59, v48, v49
    ds_write_b32 v4, v59 offset:11968
    v_pk_mul_f32 v[30:31], v[32:33], v[26:27] op_sel:[1,1] op_sel_hi:[1,0] neg_lo:[1,0]
    v_pk_fma_f32 v[32:33], v[32:33], v[26:27], v[30:31] op_sel:[0,0,0] op_sel_hi:[0,1,1]
    v_cvt_pk_bf16_f32 v56, v32, v33
    ds_write_b32 v4, v56 offset:2176
    v_pk_mul_f32 v[30:31], v[34:35], v[26:27] op_sel:[1,1] op_sel_hi:[1,0] neg_lo:[1,0]
    v_pk_fma_f32 v[34:35], v[34:35], v[26:27], v[30:31] op_sel:[0,0,0] op_sel_hi:[0,1,1]
    v_cvt_pk_bf16_f32 v57, v34, v35
    ds_write_b32 v4, v57 offset:2448
    v_pk_mul_f32 v[30:31], v[36:37], v[26:27] op_sel:[1,1] op_sel_hi:[1,0] neg_lo:[1,0]
    v_pk_fma_f32 v[36:37], v[36:37], v[26:27], v[30:31] op_sel:[0,0,0] op_sel_hi:[0,1,1]
    v_pk_mul_f32 v[52:53], v[48:49], v[28:29] op_sel:[1,1] op_sel_hi:[1,0] neg_lo:[1,0]
    v_pk_fma_f32 v[48:49], v[48:49], v[28:29], v[52:53] op_sel:[0,0,0] op_sel_hi:[0,1,1]
    v_cvt_pk_bf16_f32 v58, v48, v49
    ds_write_b32 v4, v58 offset:12240
    v_cvt_pk_bf16_f32 v59, v36, v37
    ds_write_b32 v4, v59 offset:2720
    v_pk_mul_f32 v[30:31], v[38:39], v[26:27] op_sel:[1,1] op_sel_hi:[1,0] neg_lo:[1,0]
    v_pk_fma_f32 v[38:39], v[38:39], v[26:27], v[30:31] op_sel:[0,0,0] op_sel_hi:[0,1,1]
    v_cvt_pk_bf16_f32 v56, v38, v39
    ds_write_b32 v4, v56 offset:2992
    v_pk_mul_f32 v[30:31], v[40:41], v[26:27] op_sel:[1,1] op_sel_hi:[1,0] neg_lo:[1,0]
    v_pk_fma_f32 v[40:41], v[40:41], v[26:27], v[30:31] op_sel:[0,0,0] op_sel_hi:[0,1,1]
    v_cvt_pk_bf16_f32 v57, v40, v41
    ds_write_b32 v4, v57 offset:3264
    v_pk_mul_f32 v[52:53], v[48:49], v[28:29] op_sel:[1,1] op_sel_hi:[1,0] neg_lo:[1,0]
    v_pk_fma_f32 v[48:49], v[48:49], v[28:29], v[52:53] op_sel:[0,0,0] op_sel_hi:[0,1,1]
    v_cvt_pk_bf16_f32 v58, v48, v49
    ds_write_b32 v4, v58 offset:12512
    v_pk_mul_f32 v[30:31], v[42:43], v[26:27] op_sel:[1,1] op_sel_hi:[1,0] neg_lo:[1,0]
    v_pk_fma_f32 v[42:43], v[42:43], v[26:27], v[30:31] op_sel:[0,0,0] op_sel_hi:[0,1,1]
    v_cvt_pk_bf16_f32 v59, v42, v43
    ds_write_b32 v4, v59 offset:3536
    v_pk_mul_f32 v[30:31], v[44:45], v[26:27] op_sel:[1,1] op_sel_hi:[1,0] neg_lo:[1,0]
    v_pk_fma_f32 v[44:45], v[44:45], v[26:27], v[30:31] op_sel:[0,0,0] op_sel_hi:[0,1,1]
    v_cvt_pk_bf16_f32 v56, v44, v45
    ds_write_b32 v4, v56 offset:3808
    v_pk_mul_f32 v[30:31], v[46:47], v[26:27] op_sel:[1,1] op_sel_hi:[1,0] neg_lo:[1,0]
    v_pk_fma_f32 v[46:47], v[46:47], v[26:27], v[30:31] op_sel:[0,0,0] op_sel_hi:[0,1,1]
    v_pk_mul_f32 v[52:53], v[48:49], v[28:29] op_sel:[1,1] op_sel_hi:[1,0] neg_lo:[1,0]
    v_pk_fma_f32 v[48:49], v[48:49], v[28:29], v[52:53] op_sel:[0,0,0] op_sel_hi:[0,1,1]
    v_cvt_pk_bf16_f32 v57, v48, v49
    ds_write_b32 v4, v57 offset:12784
    v_cvt_pk_bf16_f32 v58, v46, v47
    ds_write_b32 v4, v58 offset:4080
    v_pk_mul_f32 v[30:31], v[32:33], v[26:27] op_sel:[1,1] op_sel_hi:[1,0] neg_lo:[1,0]
    v_pk_fma_f32 v[32:33], v[32:33], v[26:27], v[30:31] op_sel:[0,0,0] op_sel_hi:[0,1,1]
    v_cvt_pk_bf16_f32 v59, v32, v33
    ds_write_b32 v4, v59 offset:4352
    v_pk_mul_f32 v[30:31], v[32:33], v[22:23] op_sel:[1,1] op_sel_hi:[1,0] neg_lo:[1,0]
    v_pk_fma_f32 v[34:35], v[32:33], v[22:23], v[30:31] op_sel:[0,0,0] op_sel_hi:[0,1,1]
    v_cvt_pk_bf16_f32 v56, v34, v35
    ds_write_b32 v4, v56 offset:4624
    v_pk_mul_f32 v[52:53], v[48:49], v[28:29] op_sel:[1,1] op_sel_hi:[1,0] neg_lo:[1,0]
    v_pk_fma_f32 v[48:49], v[48:49], v[28:29], v[52:53] op_sel:[0,0,0] op_sel_hi:[0,1,1]
    v_cvt_pk_bf16_f32 v57, v48, v49
    ds_write_b32 v4, v57 offset:13056
    v_pk_mul_f32 v[30:31], v[34:35], v[22:23] op_sel:[1,1] op_sel_hi:[1,0] neg_lo:[1,0]
    v_pk_fma_f32 v[36:37], v[34:35], v[22:23], v[30:31] op_sel:[0,0,0] op_sel_hi:[0,1,1]
    v_cvt_pk_bf16_f32 v58, v36, v37
    ds_write_b32 v4, v58 offset:4896
    v_pk_mul_f32 v[30:31], v[36:37], v[22:23] op_sel:[1,1] op_sel_hi:[1,0] neg_lo:[1,0]
    v_pk_fma_f32 v[38:39], v[36:37], v[22:23], v[30:31] op_sel:[0,0,0] op_sel_hi:[0,1,1]
    v_cvt_pk_bf16_f32 v59, v38, v39
    ds_write_b32 v4, v59 offset:5168
    v_pk_mul_f32 v[30:31], v[32:33], v[26:27] op_sel:[1,1] op_sel_hi:[1,0] neg_lo:[1,0]
    v_pk_fma_f32 v[32:33], v[32:33], v[26:27], v[30:31] op_sel:[0,0,0] op_sel_hi:[0,1,1]
    v_pk_mul_f32 v[52:53], v[48:49], v[28:29] op_sel:[1,1] op_sel_hi:[1,0] neg_lo:[1,0]
    v_pk_fma_f32 v[48:49], v[48:49], v[28:29], v[52:53] op_sel:[0,0,0] op_sel_hi:[0,1,1]
    v_cvt_pk_bf16_f32 v56, v48, v49
    ds_write_b32 v4, v56 offset:13328
    v_cvt_pk_bf16_f32 v57, v32, v33
    ds_write_b32 v4, v57 offset:5440
    v_pk_mul_f32 v[30:31], v[34:35], v[26:27] op_sel:[1,1] op_sel_hi:[1,0] neg_lo:[1,0]
    v_pk_fma_f32 v[34:35], v[34:35], v[26:27], v[30:31] op_sel:[0,0,0] op_sel_hi:[0,1,1]
    v_cvt_pk_bf16_f32 v58, v34, v35
    ds_write_b32 v4, v58 offset:5712
    v_pk_mul_f32 v[30:31], v[36:37], v[26:27] op_sel:[1,1] op_sel_hi:[1,0] neg_lo:[1,0]
    v_pk_fma_f32 v[36:37], v[36:37], v[26:27], v[30:31] op_sel:[0,0,0] op_sel_hi:[0,1,1]
    v_cvt_pk_bf16_f32 v59, v36, v37
    ds_write_b32 v4, v59 offset:5984
    v_pk_mul_f32 v[52:53], v[48:49], v[28:29] op_sel:[1,1] op_sel_hi:[1,0] neg_lo:[1,0]
    v_pk_fma_f32 v[48:49], v[48:49], v[28:29], v[52:53] op_sel:[0,0,0] op_sel_hi:[0,1,1]
    v_cvt_pk_bf16_f32 v56, v48, v49
    ds_write_b32 v4, v56 offset:13600
    v_pk_mul_f32 v[30:31], v[38:39], v[26:27] op_sel:[1,1] op_sel_hi:[1,0] neg_lo:[1,0]
    v_pk_fma_f32 v[38:39], v[38:39], v[26:27], v[30:31] op_sel:[0,0,0] op_sel_hi:[0,1,1]
    v_cvt_pk_bf16_f32 v57, v38, v39
    ds_write_b32 v4, v57 offset:6256
    v_pk_mul_f32 v[30:31], v[32:33], v[26:27] op_sel:[1,1] op_sel_hi:[1,0] neg_lo:[1,0]
    v_pk_fma_f32 v[32:33], v[32:33], v[26:27], v[30:31] op_sel:[0,0,0] op_sel_hi:[0,1,1]
    v_cvt_pk_bf16_f32 v58, v32, v33
    ds_write_b32 v4, v58 offset:6528
    v_pk_mul_f32 v[30:31], v[32:33], v[24:25] op_sel:[1,1] op_sel_hi:[1,0] neg_lo:[1,0]
    v_pk_fma_f32 v[34:35], v[32:33], v[24:25], v[30:31] op_sel:[0,0,0] op_sel_hi:[0,1,1]
    v_pk_mul_f32 v[52:53], v[48:49], v[28:29] op_sel:[1,1] op_sel_hi:[1,0] neg_lo:[1,0]
    v_pk_fma_f32 v[48:49], v[48:49], v[28:29], v[52:53] op_sel:[0,0,0] op_sel_hi:[0,1,1]
    v_cvt_pk_bf16_f32 v59, v48, v49
    ds_write_b32 v4, v59 offset:13872
    v_cvt_pk_bf16_f32 v56, v34, v35
    ds_write_b32 v4, v56 offset:6800
    v_pk_mul_f32 v[30:31], v[32:33], v[26:27] op_sel:[1,1] op_sel_hi:[1,0] neg_lo:[1,0]
    v_pk_fma_f32 v[32:33], v[32:33], v[26:27], v[30:31] op_sel:[0,0,0] op_sel_hi:[0,1,1]
    v_cvt_pk_bf16_f32 v57, v32, v33
    ds_write_b32 v4, v57 offset:7072
    v_pk_mul_f32 v[30:31], v[34:35], v[26:27] op_sel:[1,1] op_sel_hi:[1,0] neg_lo:[1,0]
    v_pk_fma_f32 v[34:35], v[34:35], v[26:27], v[30:31] op_sel:[0,0,0] op_sel_hi:[0,1,1]
    v_cvt_pk_bf16_f32 v58, v34, v35
    ds_write_b32 v4, v58 offset:7344
    v_pk_mul_f32 v[52:53], v[48:49], v[28:29] op_sel:[1,1] op_sel_hi:[1,0] neg_lo:[1,0]
    v_pk_fma_f32 v[48:49], v[48:49], v[28:29], v[52:53] op_sel:[0,0,0] op_sel_hi:[0,1,1]
    v_cvt_pk_bf16_f32 v59, v48, v49
    ds_write_b32 v4, v59 offset:14144
    v_pk_mul_f32 v[30:31], v[32:33], v[26:27] op_sel:[1,1] op_sel_hi:[1,0] neg_lo:[1,0]
    v_pk_fma_f32 v[32:33], v[32:33], v[26:27], v[30:31] op_sel:[0,0,0] op_sel_hi:[0,1,1]
    v_cvt_pk_bf16_f32 v56, v32, v33
    ds_write_b32 v4, v56 offset:7616
    v_pk_mul_f32 v[30:31], v[34:35], v[26:27] op_sel:[1,1] op_sel_hi:[1,0] neg_lo:[1,0]
    v_pk_fma_f32 v[34:35], v[34:35], v[26:27], v[30:31] op_sel:[0,0,0] op_sel_hi:[0,1,1]
    v_cvt_pk_bf16_f32 v57, v34, v35
    ds_write_b32 v4, v57 offset:7888
    v_pk_mul_f32 v[30:31], v[32:33], v[26:27] op_sel:[1,1] op_sel_hi:[1,0] neg_lo:[1,0]
    v_pk_fma_f32 v[32:33], v[32:33], v[26:27], v[30:31] op_sel:[0,0,0] op_sel_hi:[0,1,1]
    v_pk_mul_f32 v[52:53], v[48:49], v[28:29] op_sel:[1,1] op_sel_hi:[1,0] neg_lo:[1,0]
    v_pk_fma_f32 v[48:49], v[48:49], v[28:29], v[52:53] op_sel:[0,0,0] op_sel_hi:[0,1,1]
    v_cvt_pk_bf16_f32 v58, v48, v49
    ds_write_b32 v4, v58 offset:14416
    v_cvt_pk_bf16_f32 v59, v32, v33
    ds_write_b32 v4, v59 offset:8160
    v_pk_mul_f32 v[30:31], v[34:35], v[26:27] op_sel:[1,1] op_sel_hi:[1,0] neg_lo:[1,0]
    v_pk_fma_f32 v[34:35], v[34:35], v[26:27], v[30:31] op_sel:[0,0,0] op_sel_hi:[0,1,1]
    v_cvt_pk_bf16_f32 v56, v34, v35
    ds_write_b32 v4, v56 offset:8432
    v_pk_mul_f32 v[30:31], v[32:33], v[26:27] op_sel:[1,1] op_sel_hi:[1,0] neg_lo:[1,0]
    v_pk_fma_f32 v[32:33], v[32:33], v[26:27], v[30:31] op_sel:[0,0,0] op_sel_hi:[0,1,1]
    v_cvt_pk_bf16_f32 v57, v32, v33
    ds_write_b32 v4, v57 offset:8704
    v_pk_mul_f32 v[52:53], v[48:49], v[28:29] op_sel:[1,1] op_sel_hi:[1,0] neg_lo:[1,0]
    v_pk_fma_f32 v[48:49], v[48:49], v[28:29], v[52:53] op_sel:[0,0,0] op_sel_hi:[0,1,1]
    v_cvt_pk_bf16_f32 v58, v48, v49
    ds_write_b32 v4, v58 offset:14688
    v_pk_mul_f32 v[30:31], v[32:33], v[26:27] op_sel:[1,1] op_sel_hi:[1,0] neg_lo:[1,0]
    v_pk_fma_f32 v[32:33], v[32:33], v[26:27], v[30:31] op_sel:[0,0,0] op_sel_hi:[0,1,1]
    v_cvt_pk_bf16_f32 v59, v32, v33
    ds_write_b32 v4, v59 offset:8976
    v_pk_mul_f32 v[30:31], v[32:33], v[26:27] op_sel:[1,1] op_sel_hi:[1,0] neg_lo:[1,0]
    v_pk_fma_f32 v[32:33], v[32:33], v[26:27], v[30:31] op_sel:[0,0,0] op_sel_hi:[0,1,1]
    v_cvt_pk_bf16_f32 v56, v32, v33
    ds_write_b32 v4, v56 offset:9248
    v_pk_mul_f32 v[30:31], v[32:33], v[26:27] op_sel:[1,1] op_sel_hi:[1,0] neg_lo:[1,0]
    v_pk_fma_f32 v[32:33], v[32:33], v[26:27], v[30:31] op_sel:[0,0,0] op_sel_hi:[0,1,1]
    v_pk_mul_f32 v[52:53], v[48:49], v[28:29] op_sel:[1,1] op_sel_hi:[1,0] neg_lo:[1,0]
    v_pk_fma_f32 v[48:49], v[48:49], v[28:29], v[52:53] op_sel:[0,0,0] op_sel_hi:[0,1,1]
    v_cvt_pk_bf16_f32 v57, v48, v49
    ds_write_b32 v4, v57 offset:14960
    v_cvt_pk_bf16_f32 v58, v32, v33
    ds_write_b32 v4, v58 offset:9520
    v_pk_mul_f32 v[30:31], v[32:33], v[26:27] op_sel:[1,1] op_sel_hi:[1,0] neg_lo:[1,0]
    v_pk_fma_f32 v[32:33], v[32:33], v[26:27], v[30:31] op_sel:[0,0,0] op_sel_hi:[0,1,1]
    v_cvt_pk_bf16_f32 v59, v32, v33
    ds_write_b32 v4, v59 offset:9792
    v_pk_mul_f32 v[30:31], v[32:33], v[26:27] op_sel:[1,1] op_sel_hi:[1,0] neg_lo:[1,0]
    v_pk_fma_f32 v[32:33], v[32:33], v[26:27], v[30:31] op_sel:[0,0,0] op_sel_hi:[0,1,1]
    v_cvt_pk_bf16_f32 v56, v32, v33
    ds_write_b32 v4, v56 offset:10064
    v_pk_mul_f32 v[52:53], v[48:49], v[28:29] op_sel:[1,1] op_sel_hi:[1,0] neg_lo:[1,0]
    v_pk_fma_f32 v[48:49], v[48:49], v[28:29], v[52:53] op_sel:[0,0,0] op_sel_hi:[0,1,1]
    v_cvt_pk_bf16_f32 v57, v48, v49
    ds_write_b32 v4, v57 offset:15232
    v_pk_mul_f32 v[30:31], v[32:33], v[26:27] op_sel:[1,1] op_sel_hi:[1,0] neg_lo:[1,0]
    v_pk_fma_f32 v[32:33], v[32:33], v[26:27], v[30:31] op_sel:[0,0,0] op_sel_hi:[0,1,1]
    v_cvt_pk_bf16_f32 v58, v32, v33
    ds_write_b32 v4, v58 offset:10336
    v_pk_mul_f32 v[30:31], v[32:33], v[26:27] op_sel:[1,1] op_sel_hi:[1,0] neg_lo:[1,0]
    v_pk_fma_f32 v[32:33], v[32:33], v[26:27], v[30:31] op_sel:[0,0,0] op_sel_hi:[0,1,1]
    v_cvt_pk_bf16_f32 v59, v32, v33
    ds_write_b32 v4, v59 offset:10608
    v_pk_mul_f32 v[30:31], v[32:33], v[26:27] op_sel:[1,1] op_sel_hi:[1,0] neg_lo:[1,0]
    v_pk_fma_f32 v[32:33], v[32:33], v[26:27], v[30:31] op_sel:[0,0,0] op_sel_hi:[0,1,1]
    v_cvt_pk_bf16_f32 v56, v32, v33
    ds_write_b32 v4, v56 offset:10880
    v_mov_b32 v60, 0
    v_mov_b32 v61, 0
    v_mov_b32 v62, 0
    v_mov_b32 v63, 0
    v_mov_b32 v64, 0
    v_mov_b32 v65, 0
    v_mov_b32 v66, 0
    v_mov_b32 v67, 0
    v_mov_b32 v68, 0
    v_mov_b32 v69, 0
    v_mov_b32 v70, 0
    v_mov_b32 v71, 0
    s_waitcnt lgkmcnt(0)
    ds_read_b128 v[72:75], v5 offset:11152
    ds_read_b128 v[76:79], v5 offset:0
    ds_read_b128 v[80:83], v5 offset:4352
    ds_read_b128 v[84:87], v5 offset:8704
    ds_read_b128 v[88:91], v5 offset:11216
    ds_read_b128 v[92:95], v5 offset:64
    ds_read_b128 v[96:99], v5 offset:4416
    ds_read_b128 v[100:103], v5 offset:8768
    s_waitcnt lgkmcnt(4)
    v_mfma_f32_16x16x32_bf16 v[60:63], v[76:79], v[72:75], v[60:63]
    v_mfma_f32_16x16x32_bf16 v[64:67], v[80:83], v[72:75], v[64:67]
    v_mfma_f32_16x16x32_bf16 v[68:71], v[84:87], v[72:75], v[68:71]
    s_waitcnt lgkmcnt(0)
    v_mfma_f32_16x16x32_bf16 v[60:63], v[92:95], v[88:91], v[60:63]
    v_mfma_f32_16x16x32_bf16 v[64:67], v[96:99], v[88:91], v[64:67]
    v_mfma_f32_16x16x32_bf16 v[68:71], v[100:103], v[88:91], v[68:71]
    ds_read_b128 v[72:75], v5 offset:11280
    ds_read_b128 v[76:79], v5 offset:128
    ds_read_b128 v[80:83], v5 offset:4480
    ds_read_b128 v[84:87], v5 offset:8832
    ds_read_b128 v[88:91], v5 offset:11344
    ds_read_b128 v[92:95], v5 offset:192
    ds_read_b128 v[96:99], v5 offset:4544
    ds_read_b128 v[100:103], v5 offset:8896
    s_waitcnt lgkmcnt(4)
    v_mfma_f32_16x16x32_bf16 v[60:63], v[76:79], v[72:75], v[60:63]
    v_mfma_f32_16x16x32_bf16 v[64:67], v[80:83], v[72:75], v[64:67]
    v_mfma_f32_16x16x32_bf16 v[68:71], v[84:87], v[72:75], v[68:71]
    s_waitcnt lgkmcnt(0)
    v_mfma_f32_16x16x32_bf16 v[60:63], v[92:95], v[88:91], v[60:63]
    v_mfma_f32_16x16x32_bf16 v[64:67], v[96:99], v[88:91], v[64:67]
    v_mfma_f32_16x16x32_bf16 v[68:71], v[100:103], v[88:91], v[68:71]
    v_lshl_add_u32 v4, v1, 4, v2
    s_nop 4
    ds_write_b128 v4, v[60:63] offset:11392
    ds_write_b128 v4, v[64:67] offset:12416
    ds_write_b128 v4, v[68:71] offset:13440
kgen_skip:
    s_lshr_b32 s37, s28, 1
    s_and_b32 s38, s28, 1
    s_lshl_b32 s29, s42, 7
    v_and_b32 v17, 15, v1
    v_lshrrev_b32 v18, 4, v1
    v_and_b32 v19, 7, v17
    v_xor_b32 v19, v19, v18
    v_lshlrev_b32 v19, 4, v19
    v_lshl_add_u32 v19, v17, 7, v19
    s_lshl_b32 s30, s38, 13
    s_add_u32 s30, s30, 16384
    v_add_u32 v2, s30, v19
    v_xor_b32 v3, 64, v2
    v_add_u32 v4, 65536, v2
    v_add_u32 v5, 65536, v3
    v_add_u32 v6, 131072, v2
    v_add_u32 v7, 131072, v3
    v_bfe_u32 v17, v1, 2, 2
    v_lshl_add_u32 v19, v18, 3, v17
    v_lshlrev_b32 v19, 8, v19
    v_and_b32 v18, 1, v18
    v_lshl_add_u32 v17, v18, 2, v17
    v_lshl_add_u32 v19, v17, 5, v19
    v_and_b32 v17, 3, v1
    v_lshl_add_u32 v19, v17, 3, v19
    s_lshl_b32 s30, s38, 1
    s_add_u32 s30, s30, 0
    s_and_b32 s30, s30, 3
    s_lshl_b32 s31, s37, 2
    s_add_u32 s30, s30, s31
    s_lshl_b32 s30, s30, 5
    v_xor_b32 v8, s30, v19
    v_add_u32 v12, 65536, v8
    v_add_u32 v96, 131072, v8
    s_lshl_b32 s30, s38, 1
    s_add_u32 s30, s30, 1
    s_and_b32 s30, s30, 3
    s_lshl_b32 s31, s37, 2
    s_add_u32 s30, s30, s31
    s_lshl_b32 s30, s30, 5
    v_xor_b32 v9, s30, v19
    v_add_u32 v13, 65536, v9
    v_add_u32 v97, 131072, v9
    s_lshl_b32 s30, s38, 1
    s_add_u32 s30, s30, 2
    s_and_b32 s30, s30, 3
    s_lshl_b32 s31, s37, 2
    s_add_u32 s30, s30, s31
    s_lshl_b32 s30, s30, 5
    v_xor_b32 v10, s30, v19
    v_add_u32 v14, 65536, v10
    v_add_u32 v98, 131072, v10
    s_lshl_b32 s30, s38, 1
    s_add_u32 s30, s30, 3
    s_and_b32 s30, s30, 3
    s_lshl_b32 s31, s37, 2
    s_add_u32 s30, s30, s31
    s_lshl_b32 s30, s30, 5
    v_xor_b32 v11, s30, v19
    v_add_u32 v15, 65536, v11
    v_add_u32 v99, 131072, v11
    v_mov_b32 v24, 0
    v_mov_b32 v25, 0
    v_mov_b32 v26, 0
    v_mov_b32 v27, 0
    v_mov_b32 v28, 0
    v_mov_b32 v29, 0
    v_mov_b32 v30, 0
    v_mov_b32 v31, 0
    v_mov_b32 v32, 0
    v_mov_b32 v33, 0
    v_mov_b32 v34, 0
    v_mov_b32 v35, 0
    v_mov_b32 v36, 0
    v_mov_b32 v37, 0
    v_mov_b32 v38, 0
    v_mov_b32 v39, 0
    v_mov_b32 v40, 0
    v_mov_b32 v41, 0
    v_mov_b32 v42, 0
    v_mov_b32 v43, 0
    v_mov_b32 v44, 0
    v_mov_b32 v45, 0
    v_mov_b32 v46, 0
    v_mov_b32 v47, 0
    v_mov_b32 v48, 0
    v_mov_b32 v49, 0
    v_mov_b32 v50, 0
    v_mov_b32 v51, 0
    v_mov_b32 v52, 0
    v_mov_b32 v53, 0
    v_mov_b32 v54, 0
    v_mov_b32 v55, 0
    v_mov_b32 v56, 0
    v_mov_b32 v57, 0
    v_mov_b32 v58, 0
    v_mov_b32 v59, 0
    v_mov_b32 v60, 0
    v_mov_b32 v61, 0
    v_mov_b32 v62, 0
    v_mov_b32 v63, 0
    v_mov_b32 v64, 0
    v_mov_b32 v65, 0
    v_mov_b32 v66, 0
    v_mov_b32 v67, 0
    v_mov_b32 v68, 0
    v_mov_b32 v69, 0
    v_mov_b32 v70, 0
    v_mov_b32 v71, 0
    v_mov_b32 v72, 0
    v_mov_b32 v73, 0
    v_mov_b32 v74, 0
    v_mov_b32 v75, 0
    v_mov_b32 v76, 0
    v_mov_b32 v77, 0
    v_mov_b32 v78, 0
    v_mov_b32 v79, 0
    v_mov_b32 v80, 0
    v_mov_b32 v81, 0
    v_mov_b32 v82, 0
    v_mov_b32 v83, 0
    v_mov_b32 v84, 0
    v_mov_b32 v85, 0
    v_mov_b32 v86, 0
    v_mov_b32 v87, 0
    v_mov_b32 v88, 0
    v_mov_b32 v89, 0
    v_mov_b32 v90, 0
    v_mov_b32 v91, 0
    v_mov_b32 v92, 0
    v_mov_b32 v93, 0
    v_mov_b32 v94, 0
    v_mov_b32 v95, 0
    v_mov_b32 v20, 0x3f803f80
    v_mov_b32 v21, 0x3f803f80
    v_mov_b32 v22, 0x3f803f80
    v_mov_b32 v23, 0x3f803f80
    v_lshrrev_b32 v17, 4, v1
    v_lshlrev_b32 v17, 3, v17
    s_lshl_b32 s30, s41, 8
    s_lshl_b32 s31, s38, 1
    s_add_u32 s31, s31, 0
    s_and_b32 s31, s31, 3
    s_lshl_b32 s33, s37, 2
    s_add_u32 s31, s31, s33
    s_lshl_b32 s31, s31, 5
    s_add_u32 s31, s31, s30
    buffer_load_dwordx2 v[168:169], v17, s[20:23], s31 offen
    s_lshl_b32 s31, s38, 1
    s_add_u32 s31, s31, 1
    s_and_b32 s31, s31, 3
    s_lshl_b32 s33, s37, 2
    s_add_u32 s31, s31, s33
    s_lshl_b32 s31, s31, 5
    s_add_u32 s31, s31, s30
    buffer_load_dwordx2 v[170:171], v17, s[20:23], s31 offen
    s_lshl_b32 s31, s38, 1
    s_add_u32 s31, s31, 2
    s_and_b32 s31, s31, 3
    s_lshl_b32 s33, s37, 2
    s_add_u32 s31, s31, s33
    s_lshl_b32 s31, s31, 5
    s_add_u32 s31, s31, s30
    buffer_load_dwordx2 v[172:173], v17, s[20:23], s31 offen
    s_lshl_b32 s31, s38, 1
    s_add_u32 s31, s31, 3
    s_and_b32 s31, s31, 3
    s_lshl_b32 s33, s37, 2
    s_add_u32 s31, s31, s33
    s_lshl_b32 s31, s31, 5
    s_add_u32 s31, s31, s30
    buffer_load_dwordx2 v[174:175], v17, s[20:23], s31 offen
    s_lshl_b32 s30, s28, 2
    s_add_u32 s30, s30, 163776
    v_mov_b32 v228, s30
    v_mov_b32 v229, 0
    ds_write_b32 v228, v229
    ds_write_b32 v228, v229 offset:0
    v_subrev_u32 v16, 16, v228
    ds_write_b32 v16, v229
    s_waitcnt vmcnt(0) lgkmcnt(0)
    v_readfirstlane_b32 s60, v140
    s_nop 3
    s_cmp_lg_u32 s60, 0
    s_cbranch_scc1 nonce_ok2
    s_mov_b32 s4, s90
    s_and_b32 s5, s91, 0xffff
    s_mov_b32 s6, 256
    s_mov_b32 s7, 0x00020000
    s_mov_b32 s61, 0
    v_mov_b32 v141, 0
nonce_spin2:
    buffer_load_dword v140, v141, s[4:7], 0 offen sc1
    s_waitcnt vmcnt(0)
    v_readfirstlane_b32 s60, v140
    s_nop 3
    s_cmp_lg_u32 s60, 0
    s_cbranch_scc1 nonce_ok2
    s_sleep 1
    s_add_u32 s61, s61, 1
    s_cmp_lt_u32 s61, 0x8000
    s_cbranch_scc1 nonce_spin2
nonce_ok2:
    s_barrier
    ds_read_b64_tr_b16 v[104:105], v8 offset:0
    ds_read_b64_tr_b16 v[106:107], v8 offset:1024
    ds_read_b128 v[136:139], v2 offset:0
    ds_read_b128 v[140:143], v2 offset:2048
    ds_read_b128 v[144:147], v2 offset:4096
    ds_read_b128 v[148:151], v2 offset:6144
    ds_read_b64_tr_b16 v[108:109], v9 offset:0
    ds_read_b64_tr_b16 v[110:111], v9 offset:1024
    ds_read_b64_tr_b16 v[112:113], v10 offset:0
    ds_read_b64_tr_b16 v[114:115], v10 offset:1024
    ds_read_b64_tr_b16 v[116:117], v11 offset:0
    ds_read_b64_tr_b16 v[118:119], v11 offset:1024
    s_waitcnt lgkmcnt(0)
.p2align 3
    v_mfma_f32_16x16x32_bf16 v[24:27], v[104:107], v[136:139], v[24:27]
    ds_read_b64_tr_b16 v[120:121], v8 offset:8192
    v_mfma_f32_16x16x32_bf16 v[28:31], v[104:107], v[140:143], v[28:31]
    ds_read_b64_tr_b16 v[122:123], v8 offset:9216
    v_mfma_f32_16x16x32_bf16 v[32:35], v[104:107], v[144:147], v[32:35]
    ds_read_b128 v[152:155], v3 offset:0
    v_mfma_f32_16x16x32_bf16 v[36:39], v[104:107], v[148:151], v[36:39]
    ds_read_b128 v[156:159], v3 offset:2048
    v_mfma_f32_16x16x32_bf16 v[88:91], v[104:107], v[20:23], v[88:91]
    ds_read_b128 v[160:163], v3 offset:4096
    v_mfma_f32_16x16x32_bf16 v[40:43], v[108:111], v[136:139], v[40:43]
    ds_read_b128 v[164:167], v3 offset:6144
    v_mfma_f32_16x16x32_bf16 v[44:47], v[108:111], v[140:143], v[44:47]
    ds_read_b64_tr_b16 v[124:125], v9 offset:8192
    v_mfma_f32_16x16x32_bf16 v[48:51], v[108:111], v[144:147], v[48:51]
    ds_read_b64_tr_b16 v[126:127], v9 offset:9216
    v_mfma_f32_16x16x32_bf16 v[52:55], v[108:111], v[148:151], v[52:55]
    ds_read_b64_tr_b16 v[128:129], v10 offset:8192
    v_mfma_f32_16x16x32_bf16 v[92:95], v[108:111], v[20:23], v[92:95]
    ds_read_b64_tr_b16 v[130:131], v10 offset:9216
    v_mfma_f32_16x16x32_bf16 v[56:59], v[112:115], v[136:139], v[56:59]
    ds_read_b64_tr_b16 v[132:133], v11 offset:8192
    v_mfma_f32_16x16x32_bf16 v[60:63], v[112:115], v[140:143], v[60:63]
    ds_read_b64_tr_b16 v[134:135], v11 offset:9216
    v_mfma_f32_16x16x32_bf16 v[64:67], v[112:115], v[144:147], v[64:67]
    v_mfma_f32_16x16x32_bf16 v[68:71], v[112:115], v[148:151], v[68:71]
    v_mfma_f32_16x16x32_bf16 v[72:75], v[116:119], v[136:139], v[72:75]
    v_mfma_f32_16x16x32_bf16 v[76:79], v[116:119], v[140:143], v[76:79]
    v_mfma_f32_16x16x32_bf16 v[80:83], v[116:119], v[144:147], v[80:83]
    v_mfma_f32_16x16x32_bf16 v[84:87], v[116:119], v[148:151], v[84:87]
    s_waitcnt lgkmcnt(0)
    s_barrier
.p2align 3
    v_mfma_f32_16x16x32_bf16 v[24:27], v[120:123], v[152:155], v[24:27]
    ds_read_b64_tr_b16 v[104:105], v8 offset:32768
    v_mfma_f32_16x16x32_bf16 v[28:31], v[120:123], v[156:159], v[28:31]
    ds_read_b64_tr_b16 v[106:107], v8 offset:33792
    v_mfma_f32_16x16x32_bf16 v[32:35], v[120:123], v[160:163], v[32:35]
    ds_read_b128 v[136:139], v2 offset:32768
    v_mfma_f32_16x16x32_bf16 v[36:39], v[120:123], v[164:167], v[36:39]
    ds_read_b128 v[140:143], v2 offset:34816
    v_mfma_f32_16x16x32_bf16 v[88:91], v[120:123], v[20:23], v[88:91]
    ds_read_b128 v[144:147], v2 offset:36864
    v_mfma_f32_16x16x32_bf16 v[40:43], v[124:127], v[152:155], v[40:43]
    ds_read_b128 v[148:151], v2 offset:38912
    v_mfma_f32_16x16x32_bf16 v[44:47], v[124:127], v[156:159], v[44:47]
    ds_read_b64_tr_b16 v[108:109], v9 offset:32768
    v_mfma_f32_16x16x32_bf16 v[48:51], v[124:127], v[160:163], v[48:51]
    ds_read_b64_tr_b16 v[110:111], v9 offset:33792
    v_mfma_f32_16x16x32_bf16 v[52:55], v[124:127], v[164:167], v[52:55]
    ds_read_b64_tr_b16 v[112:113], v10 offset:32768
    v_mfma_f32_16x16x32_bf16 v[92:95], v[124:127], v[20:23], v[92:95]
    ds_read_b64_tr_b16 v[114:115], v10 offset:33792
    v_mfma_f32_16x16x32_bf16 v[56:59], v[128:131], v[152:155], v[56:59]
    ds_read_b64_tr_b16 v[116:117], v11 offset:32768
    v_mfma_f32_16x16x32_bf16 v[60:63], v[128:131], v[156:159], v[60:63]
    ds_read_b64_tr_b16 v[118:119], v11 offset:33792
    v_mfma_f32_16x16x32_bf16 v[64:67], v[128:131], v[160:163], v[64:67]
    v_mfma_f32_16x16x32_bf16 v[68:71], v[128:131], v[164:167], v[68:71]
    v_mfma_f32_16x16x32_bf16 v[72:75], v[132:135], v[152:155], v[72:75]
    v_mfma_f32_16x16x32_bf16 v[76:79], v[132:135], v[156:159], v[76:79]
    v_mfma_f32_16x16x32_bf16 v[80:83], v[132:135], v[160:163], v[80:83]
    v_mfma_f32_16x16x32_bf16 v[84:87], v[132:135], v[164:167], v[84:87]
    v_lshlrev_b32 v230, 4, v1
    v_add_u32 v230, s55, v230
    ds_write_b128 v230, v[232:235]
    ds_write_b128 v230, v[236:239] offset:1024
    s_waitcnt lgkmcnt(0)
.p2align 3
    v_mfma_f32_16x16x32_bf16 v[24:27], v[104:107], v[136:139], v[24:27]
    ds_read_b64_tr_b16 v[120:121], v8 offset:40960
    v_mfma_f32_16x16x32_bf16 v[28:31], v[104:107], v[140:143], v[28:31]
    ds_read_b64_tr_b16 v[122:123], v8 offset:41984
    v_mfma_f32_16x16x32_bf16 v[32:35], v[104:107], v[144:147], v[32:35]
    ds_read_b128 v[152:155], v3 offset:32768
    v_mfma_f32_16x16x32_bf16 v[36:39], v[104:107], v[148:151], v[36:39]
    ds_read_b128 v[156:159], v3 offset:34816
    v_mfma_f32_16x16x32_bf16 v[88:91], v[104:107], v[20:23], v[88:91]
    ds_read_b128 v[160:163], v3 offset:36864
    v_mfma_f32_16x16x32_bf16 v[40:43], v[108:111], v[136:139], v[40:43]
    ds_read_b128 v[164:167], v3 offset:38912
    v_mfma_f32_16x16x32_bf16 v[44:47], v[108:111], v[140:143], v[44:47]
    ds_read_b64_tr_b16 v[124:125], v9 offset:40960
    v_mfma_f32_16x16x32_bf16 v[48:51], v[108:111], v[144:147], v[48:51]
    ds_read_b64_tr_b16 v[126:127], v9 offset:41984
    v_mfma_f32_16x16x32_bf16 v[52:55], v[108:111], v[148:151], v[52:55]
    ds_read_b64_tr_b16 v[128:129], v10 offset:40960
    v_mfma_f32_16x16x32_bf16 v[92:95], v[108:111], v[20:23], v[92:95]
    ds_read_b64_tr_b16 v[130:131], v10 offset:41984
    v_mfma_f32_16x16x32_bf16 v[56:59], v[112:115], v[136:139], v[56:59]
    ds_read_b64_tr_b16 v[132:133], v11 offset:40960
    v_mfma_f32_16x16x32_bf16 v[60:63], v[112:115], v[140:143], v[60:63]
    ds_read_b64_tr_b16 v[134:135], v11 offset:41984
    v_mfma_f32_16x16x32_bf16 v[64:67], v[112:115], v[144:147], v[64:67]
    v_mfma_f32_16x16x32_bf16 v[68:71], v[112:115], v[148:151], v[68:71]
    v_mfma_f32_16x16x32_bf16 v[72:75], v[116:119], v[136:139], v[72:75]
    v_mfma_f32_16x16x32_bf16 v[76:79], v[116:119], v[140:143], v[76:79]
    v_mfma_f32_16x16x32_bf16 v[80:83], v[116:119], v[144:147], v[80:83]
    v_mfma_f32_16x16x32_bf16 v[84:87], v[116:119], v[148:151], v[84:87]
    v_lshrrev_b32 v230, 2, v1
    v_lshlrev_b32 v230, 6, v230
    v_and_b32 v231, 3, v1
    v_lshl_add_u32 v230, v231, 3, v230
    v_add_u32 v230, s55, v230
    ds_read_b64_tr_b16 v[232:233], v230
    ds_read_b64_tr_b16 v[234:235], v230 offset:1024
    ds_read_b64_tr_b16 v[236:237], v230 offset:32
    ds_read_b64_tr_b16 v[238:239], v230 offset:1056
    s_waitcnt lgkmcnt(0)
    s_barrier
.p2align 3
    v_mfma_f32_16x16x32_bf16 v[24:27], v[120:123], v[152:155], v[24:27]
    ds_read_b64_tr_b16 v[104:105], v12 offset:0
    v_mfma_f32_16x16x32_bf16 v[28:31], v[120:123], v[156:159], v[28:31]
    ds_read_b64_tr_b16 v[106:107], v12 offset:1024
    v_mfma_f32_16x16x32_bf16 v[32:35], v[120:123], v[160:163], v[32:35]
    ds_read_b128 v[136:139], v4 offset:0
    v_mfma_f32_16x16x32_bf16 v[36:39], v[120:123], v[164:167], v[36:39]
    ds_read_b128 v[140:143], v4 offset:2048
    v_mfma_f32_16x16x32_bf16 v[88:91], v[120:123], v[20:23], v[88:91]
    ds_read_b128 v[144:147], v4 offset:4096
    v_mfma_f32_16x16x32_bf16 v[40:43], v[124:127], v[152:155], v[40:43]
    ds_read_b128 v[148:151], v4 offset:6144
    v_mfma_f32_16x16x32_bf16 v[44:47], v[124:127], v[156:159], v[44:47]
    ds_read_b64_tr_b16 v[108:109], v13 offset:0
    v_mfma_f32_16x16x32_bf16 v[48:51], v[124:127], v[160:163], v[48:51]
    ds_read_b64_tr_b16 v[110:111], v13 offset:1024
    v_mfma_f32_16x16x32_bf16 v[52:55], v[124:127], v[164:167], v[52:55]
    ds_read_b64_tr_b16 v[112:113], v14 offset:0
    v_mfma_f32_16x16x32_bf16 v[92:95], v[124:127], v[20:23], v[92:95]
    ds_read_b64_tr_b16 v[114:115], v14 offset:1024
    v_mfma_f32_16x16x32_bf16 v[56:59], v[128:131], v[152:155], v[56:59]
    ds_read_b64_tr_b16 v[116:117], v15 offset:0
    v_mfma_f32_16x16x32_bf16 v[60:63], v[128:131], v[156:159], v[60:63]
    ds_read_b64_tr_b16 v[118:119], v15 offset:1024
    v_mfma_f32_16x16x32_bf16 v[64:67], v[128:131], v[160:163], v[64:67]
    v_mfma_f32_16x16x32_bf16 v[68:71], v[128:131], v[164:167], v[68:71]
    v_mfma_f32_16x16x32_bf16 v[72:75], v[132:135], v[152:155], v[72:75]
    v_mfma_f32_16x16x32_bf16 v[76:79], v[132:135], v[156:159], v[76:79]
    v_mfma_f32_16x16x32_bf16 v[80:83], v[132:135], v[160:163], v[80:83]
    v_mfma_f32_16x16x32_bf16 v[84:87], v[132:135], v[164:167], v[84:87]
    s_mul_i32 s30, s51, 108
    s_add_u32 s30, s30, s50
    s_lshl_b32 s30, s30, 10
    s_add_u32 s30, s30, 2818048
    v_lshlrev_b32 v230, 4, v1
    s_add_u32 s31, s30, 55296
    buffer_store_dwordx4 v[232:235], v230, s[16:19], s30 offen sc1
    buffer_store_dwordx4 v[236:239], v230, s[16:19], s31 offen sc1
    s_waitcnt lgkmcnt(0)
.p2align 3
    v_mfma_f32_16x16x32_bf16 v[24:27], v[104:107], v[136:139], v[24:27]
    ds_read_b64_tr_b16 v[120:121], v12 offset:8192
    v_mfma_f32_16x16x32_bf16 v[28:31], v[104:107], v[140:143], v[28:31]
    ds_read_b64_tr_b16 v[122:123], v12 offset:9216
    v_mfma_f32_16x16x32_bf16 v[32:35], v[104:107], v[144:147], v[32:35]
    ds_read_b128 v[152:155], v5 offset:0
    v_mfma_f32_16x16x32_bf16 v[36:39], v[104:107], v[148:151], v[36:39]
    ds_read_b128 v[156:159], v5 offset:2048
    v_mfma_f32_16x16x32_bf16 v[88:91], v[104:107], v[20:23], v[88:91]
    ds_read_b128 v[160:163], v5 offset:4096
    v_mfma_f32_16x16x32_bf16 v[40:43], v[108:111], v[136:139], v[40:43]
    ds_read_b128 v[164:167], v5 offset:6144
    v_mfma_f32_16x16x32_bf16 v[44:47], v[108:111], v[140:143], v[44:47]
    ds_read_b64_tr_b16 v[124:125], v13 offset:8192
    v_mfma_f32_16x16x32_bf16 v[48:51], v[108:111], v[144:147], v[48:51]
    ds_read_b64_tr_b16 v[126:127], v13 offset:9216
    v_mfma_f32_16x16x32_bf16 v[52:55], v[108:111], v[148:151], v[52:55]
    ds_read_b64_tr_b16 v[128:129], v14 offset:8192
    v_mfma_f32_16x16x32_bf16 v[92:95], v[108:111], v[20:23], v[92:95]
    ds_read_b64_tr_b16 v[130:131], v14 offset:9216
    v_mfma_f32_16x16x32_bf16 v[56:59], v[112:115], v[136:139], v[56:59]
    ds_read_b64_tr_b16 v[132:133], v15 offset:8192
    v_mfma_f32_16x16x32_bf16 v[60:63], v[112:115], v[140:143], v[60:63]
    ds_read_b64_tr_b16 v[134:135], v15 offset:9216
    v_mfma_f32_16x16x32_bf16 v[64:67], v[112:115], v[144:147], v[64:67]
    v_mfma_f32_16x16x32_bf16 v[68:71], v[112:115], v[148:151], v[68:71]
    v_mfma_f32_16x16x32_bf16 v[72:75], v[116:119], v[136:139], v[72:75]
    v_mfma_f32_16x16x32_bf16 v[76:79], v[116:119], v[140:143], v[76:79]
    v_mfma_f32_16x16x32_bf16 v[80:83], v[116:119], v[144:147], v[80:83]
    v_mfma_f32_16x16x32_bf16 v[84:87], v[116:119], v[148:151], v[84:87]
    s_waitcnt lgkmcnt(0)
    s_barrier
.p2align 3
    v_mfma_f32_16x16x32_bf16 v[24:27], v[120:123], v[152:155], v[24:27]
    ds_read_b64_tr_b16 v[104:105], v8 offset:0
    v_mfma_f32_16x16x32_bf16 v[28:31], v[120:123], v[156:159], v[28:31]
    ds_read_b64_tr_b16 v[106:107], v8 offset:1024
    v_mfma_f32_16x16x32_bf16 v[32:35], v[120:123], v[160:163], v[32:35]
    ds_read_b128 v[136:139], v2 offset:0
    v_mfma_f32_16x16x32_bf16 v[36:39], v[120:123], v[164:167], v[36:39]
    ds_read_b128 v[140:143], v2 offset:2048
    v_mfma_f32_16x16x32_bf16 v[88:91], v[120:123], v[20:23], v[88:91]
    ds_read_b128 v[144:147], v2 offset:4096
    v_mfma_f32_16x16x32_bf16 v[40:43], v[124:127], v[152:155], v[40:43]
    ds_read_b128 v[148:151], v2 offset:6144
    v_mfma_f32_16x16x32_bf16 v[44:47], v[124:127], v[156:159], v[44:47]
    ds_read_b64_tr_b16 v[108:109], v9 offset:0
    v_mfma_f32_16x16x32_bf16 v[48:51], v[124:127], v[160:163], v[48:51]
    ds_read_b64_tr_b16 v[110:111], v9 offset:1024
    v_mfma_f32_16x16x32_bf16 v[52:55], v[124:127], v[164:167], v[52:55]
    ds_read_b64_tr_b16 v[112:113], v10 offset:0
    v_mfma_f32_16x16x32_bf16 v[92:95], v[124:127], v[20:23], v[92:95]
    ds_read_b64_tr_b16 v[114:115], v10 offset:1024
    v_mfma_f32_16x16x32_bf16 v[56:59], v[128:131], v[152:155], v[56:59]
    ds_read_b64_tr_b16 v[116:117], v11 offset:0
    v_mfma_f32_16x16x32_bf16 v[60:63], v[128:131], v[156:159], v[60:63]
    ds_read_b64_tr_b16 v[118:119], v11 offset:1024
    v_mfma_f32_16x16x32_bf16 v[64:67], v[128:131], v[160:163], v[64:67]
    v_mfma_f32_16x16x32_bf16 v[68:71], v[128:131], v[164:167], v[68:71]
    v_mfma_f32_16x16x32_bf16 v[72:75], v[132:135], v[152:155], v[72:75]
    v_mfma_f32_16x16x32_bf16 v[76:79], v[132:135], v[156:159], v[76:79]
    v_mfma_f32_16x16x32_bf16 v[80:83], v[132:135], v[160:163], v[80:83]
    v_mfma_f32_16x16x32_bf16 v[84:87], v[132:135], v[164:167], v[84:87]
    s_waitcnt lgkmcnt(0)
.p2align 3
    v_mfma_f32_16x16x32_bf16 v[24:27], v[104:107], v[136:139], v[24:27]
    ds_read_b64_tr_b16 v[120:121], v8 offset:8192
    v_mfma_f32_16x16x32_bf16 v[28:31], v[104:107], v[140:143], v[28:31]
    ds_read_b64_tr_b16 v[122:123], v8 offset:9216
    v_mfma_f32_16x16x32_bf16 v[32:35], v[104:107], v[144:147], v[32:35]
    ds_read_b128 v[152:155], v3 offset:0
    v_mfma_f32_16x16x32_bf16 v[36:39], v[104:107], v[148:151], v[36:39]
    ds_read_b128 v[156:159], v3 offset:2048
    v_mfma_f32_16x16x32_bf16 v[88:91], v[104:107], v[20:23], v[88:91]
    ds_read_b128 v[160:163], v3 offset:4096
    v_mfma_f32_16x16x32_bf16 v[40:43], v[108:111], v[136:139], v[40:43]
    ds_read_b128 v[164:167], v3 offset:6144
    v_mfma_f32_16x16x32_bf16 v[44:47], v[108:111], v[140:143], v[44:47]
    ds_read_b64_tr_b16 v[124:125], v9 offset:8192
    v_mfma_f32_16x16x32_bf16 v[48:51], v[108:111], v[144:147], v[48:51]
    ds_read_b64_tr_b16 v[126:127], v9 offset:9216
    v_mfma_f32_16x16x32_bf16 v[52:55], v[108:111], v[148:151], v[52:55]
    ds_read_b64_tr_b16 v[128:129], v10 offset:8192
    v_mfma_f32_16x16x32_bf16 v[92:95], v[108:111], v[20:23], v[92:95]
    ds_read_b64_tr_b16 v[130:131], v10 offset:9216
    v_mfma_f32_16x16x32_bf16 v[56:59], v[112:115], v[136:139], v[56:59]
    ds_read_b64_tr_b16 v[132:133], v11 offset:8192
    v_mfma_f32_16x16x32_bf16 v[60:63], v[112:115], v[140:143], v[60:63]
    ds_read_b64_tr_b16 v[134:135], v11 offset:9216
    v_mfma_f32_16x16x32_bf16 v[64:67], v[112:115], v[144:147], v[64:67]
    v_mfma_f32_16x16x32_bf16 v[68:71], v[112:115], v[148:151], v[68:71]
    v_mfma_f32_16x16x32_bf16 v[72:75], v[116:119], v[136:139], v[72:75]
    v_mfma_f32_16x16x32_bf16 v[76:79], v[116:119], v[140:143], v[76:79]
    v_mfma_f32_16x16x32_bf16 v[80:83], v[116:119], v[144:147], v[80:83]
    v_mfma_f32_16x16x32_bf16 v[84:87], v[116:119], v[148:151], v[84:87]
    s_waitcnt lgkmcnt(0)
    s_barrier
.p2align 3
    v_mfma_f32_16x16x32_bf16 v[24:27], v[120:123], v[152:155], v[24:27]
    ds_read_b64_tr_b16 v[104:105], v8 offset:32768
    v_mfma_f32_16x16x32_bf16 v[28:31], v[120:123], v[156:159], v[28:31]
    ds_read_b64_tr_b16 v[106:107], v8 offset:33792
    v_mfma_f32_16x16x32_bf16 v[32:35], v[120:123], v[160:163], v[32:35]
    ds_read_b128 v[136:139], v2 offset:32768
    v_mfma_f32_16x16x32_bf16 v[36:39], v[120:123], v[164:167], v[36:39]
    ds_read_b128 v[140:143], v2 offset:34816
    v_mfma_f32_16x16x32_bf16 v[88:91], v[120:123], v[20:23], v[88:91]
    ds_read_b128 v[144:147], v2 offset:36864
    v_mfma_f32_16x16x32_bf16 v[40:43], v[124:127], v[152:155], v[40:43]
    ds_read_b128 v[148:151], v2 offset:38912
    v_mfma_f32_16x16x32_bf16 v[44:47], v[124:127], v[156:159], v[44:47]
    ds_read_b64_tr_b16 v[108:109], v9 offset:32768
    v_mfma_f32_16x16x32_bf16 v[48:51], v[124:127], v[160:163], v[48:51]
    ds_read_b64_tr_b16 v[110:111], v9 offset:33792
    v_mfma_f32_16x16x32_bf16 v[52:55], v[124:127], v[164:167], v[52:55]
    ds_read_b64_tr_b16 v[112:113], v10 offset:32768
    v_mfma_f32_16x16x32_bf16 v[92:95], v[124:127], v[20:23], v[92:95]
    ds_read_b64_tr_b16 v[114:115], v10 offset:33792
    v_mfma_f32_16x16x32_bf16 v[56:59], v[128:131], v[152:155], v[56:59]
    ds_read_b64_tr_b16 v[116:117], v11 offset:32768
    v_mfma_f32_16x16x32_bf16 v[60:63], v[128:131], v[156:159], v[60:63]
    ds_read_b64_tr_b16 v[118:119], v11 offset:33792
    v_mfma_f32_16x16x32_bf16 v[64:67], v[128:131], v[160:163], v[64:67]
    v_mfma_f32_16x16x32_bf16 v[68:71], v[128:131], v[164:167], v[68:71]
    v_mfma_f32_16x16x32_bf16 v[72:75], v[132:135], v[152:155], v[72:75]
    v_mfma_f32_16x16x32_bf16 v[76:79], v[132:135], v[156:159], v[76:79]
    v_mfma_f32_16x16x32_bf16 v[80:83], v[132:135], v[160:163], v[80:83]
    v_mfma_f32_16x16x32_bf16 v[84:87], v[132:135], v[164:167], v[84:87]
    s_waitcnt lgkmcnt(0)
.p2align 3
    v_mfma_f32_16x16x32_bf16 v[24:27], v[104:107], v[136:139], v[24:27]
    ds_read_b64_tr_b16 v[120:121], v8 offset:40960
    v_mfma_f32_16x16x32_bf16 v[28:31], v[104:107], v[140:143], v[28:31]
    ds_read_b64_tr_b16 v[122:123], v8 offset:41984
    v_mfma_f32_16x16x32_bf16 v[32:35], v[104:107], v[144:147], v[32:35]
    ds_read_b128 v[152:155], v3 offset:32768
    v_mfma_f32_16x16x32_bf16 v[36:39], v[104:107], v[148:151], v[36:39]
    ds_read_b128 v[156:159], v3 offset:34816
    v_mfma_f32_16x16x32_bf16 v[88:91], v[104:107], v[20:23], v[88:91]
    ds_read_b128 v[160:163], v3 offset:36864
    v_mfma_f32_16x16x32_bf16 v[40:43], v[108:111], v[136:139], v[40:43]
    ds_read_b128 v[164:167], v3 offset:38912
    v_mfma_f32_16x16x32_bf16 v[44:47], v[108:111], v[140:143], v[44:47]
    ds_read_b64_tr_b16 v[124:125], v9 offset:40960
    v_mfma_f32_16x16x32_bf16 v[48:51], v[108:111], v[144:147], v[48:51]
    ds_read_b64_tr_b16 v[126:127], v9 offset:41984
    v_mfma_f32_16x16x32_bf16 v[52:55], v[108:111], v[148:151], v[52:55]
    ds_read_b64_tr_b16 v[128:129], v10 offset:40960
    v_mfma_f32_16x16x32_bf16 v[92:95], v[108:111], v[20:23], v[92:95]
    ds_read_b64_tr_b16 v[130:131], v10 offset:41984
    v_mfma_f32_16x16x32_bf16 v[56:59], v[112:115], v[136:139], v[56:59]
    ds_read_b64_tr_b16 v[132:133], v11 offset:40960
    v_mfma_f32_16x16x32_bf16 v[60:63], v[112:115], v[140:143], v[60:63]
    ds_read_b64_tr_b16 v[134:135], v11 offset:41984
    v_mfma_f32_16x16x32_bf16 v[64:67], v[112:115], v[144:147], v[64:67]
    v_mfma_f32_16x16x32_bf16 v[68:71], v[112:115], v[148:151], v[68:71]
    v_mfma_f32_16x16x32_bf16 v[72:75], v[116:119], v[136:139], v[72:75]
    v_mfma_f32_16x16x32_bf16 v[76:79], v[116:119], v[140:143], v[76:79]
    v_mfma_f32_16x16x32_bf16 v[80:83], v[116:119], v[144:147], v[80:83]
    v_mfma_f32_16x16x32_bf16 v[84:87], v[116:119], v[148:151], v[84:87]
    s_waitcnt lgkmcnt(0)
    s_barrier
.p2align 3
    v_mfma_f32_16x16x32_bf16 v[24:27], v[120:123], v[152:155], v[24:27]
    ds_read_b64_tr_b16 v[104:105], v12 offset:0
    v_mfma_f32_16x16x32_bf16 v[28:31], v[120:123], v[156:159], v[28:31]
    ds_read_b64_tr_b16 v[106:107], v12 offset:1024
    v_mfma_f32_16x16x32_bf16 v[32:35], v[120:123], v[160:163], v[32:35]
    ds_read_b128 v[136:139], v4 offset:0
    v_mfma_f32_16x16x32_bf16 v[36:39], v[120:123], v[164:167], v[36:39]
    ds_read_b128 v[140:143], v4 offset:2048
    v_mfma_f32_16x16x32_bf16 v[88:91], v[120:123], v[20:23], v[88:91]
    ds_read_b128 v[144:147], v4 offset:4096
    v_mfma_f32_16x16x32_bf16 v[40:43], v[124:127], v[152:155], v[40:43]
    ds_read_b128 v[148:151], v4 offset:6144
    v_mfma_f32_16x16x32_bf16 v[44:47], v[124:127], v[156:159], v[44:47]
    ds_read_b64_tr_b16 v[108:109], v13 offset:0
    v_mfma_f32_16x16x32_bf16 v[48:51], v[124:127], v[160:163], v[48:51]
    ds_read_b64_tr_b16 v[110:111], v13 offset:1024
    v_mfma_f32_16x16x32_bf16 v[52:55], v[124:127], v[164:167], v[52:55]
    ds_read_b64_tr_b16 v[112:113], v14 offset:0
    v_mfma_f32_16x16x32_bf16 v[92:95], v[124:127], v[20:23], v[92:95]
    ds_read_b64_tr_b16 v[114:115], v14 offset:1024
    v_mfma_f32_16x16x32_bf16 v[56:59], v[128:131], v[152:155], v[56:59]
    ds_read_b64_tr_b16 v[116:117], v15 offset:0
    v_mfma_f32_16x16x32_bf16 v[60:63], v[128:131], v[156:159], v[60:63]
    ds_read_b64_tr_b16 v[118:119], v15 offset:1024
    v_mfma_f32_16x16x32_bf16 v[64:67], v[128:131], v[160:163], v[64:67]
    v_mfma_f32_16x16x32_bf16 v[68:71], v[128:131], v[164:167], v[68:71]
    v_mfma_f32_16x16x32_bf16 v[72:75], v[132:135], v[152:155], v[72:75]
    v_mfma_f32_16x16x32_bf16 v[76:79], v[132:135], v[156:159], v[76:79]
    v_mfma_f32_16x16x32_bf16 v[80:83], v[132:135], v[160:163], v[80:83]
    v_mfma_f32_16x16x32_bf16 v[84:87], v[132:135], v[164:167], v[84:87]
    s_waitcnt lgkmcnt(0)
.p2align 3
    v_mfma_f32_16x16x32_bf16 v[24:27], v[104:107], v[136:139], v[24:27]
    ds_read_b64_tr_b16 v[120:121], v12 offset:8192
    v_mfma_f32_16x16x32_bf16 v[28:31], v[104:107], v[140:143], v[28:31]
    ds_read_b64_tr_b16 v[122:123], v12 offset:9216
    v_mfma_f32_16x16x32_bf16 v[32:35], v[104:107], v[144:147], v[32:35]
    ds_read_b128 v[152:155], v5 offset:0
    v_mfma_f32_16x16x32_bf16 v[36:39], v[104:107], v[148:151], v[36:39]
    ds_read_b128 v[156:159], v5 offset:2048
    v_mfma_f32_16x16x32_bf16 v[88:91], v[104:107], v[20:23], v[88:91]
    ds_read_b128 v[160:163], v5 offset:4096
    v_mfma_f32_16x16x32_bf16 v[40:43], v[108:111], v[136:139], v[40:43]
    ds_read_b128 v[164:167], v5 offset:6144
    v_mfma_f32_16x16x32_bf16 v[44:47], v[108:111], v[140:143], v[44:47]
    ds_read_b64_tr_b16 v[124:125], v13 offset:8192
    v_mfma_f32_16x16x32_bf16 v[48:51], v[108:111], v[144:147], v[48:51]
    ds_read_b64_tr_b16 v[126:127], v13 offset:9216
    v_mfma_f32_16x16x32_bf16 v[52:55], v[108:111], v[148:151], v[52:55]
    ds_read_b64_tr_b16 v[128:129], v14 offset:8192
    v_mfma_f32_16x16x32_bf16 v[92:95], v[108:111], v[20:23], v[92:95]
    ds_read_b64_tr_b16 v[130:131], v14 offset:9216
    v_mfma_f32_16x16x32_bf16 v[56:59], v[112:115], v[136:139], v[56:59]
    ds_read_b64_tr_b16 v[132:133], v15 offset:8192
    v_mfma_f32_16x16x32_bf16 v[60:63], v[112:115], v[140:143], v[60:63]
    ds_read_b64_tr_b16 v[134:135], v15 offset:9216
    v_mfma_f32_16x16x32_bf16 v[64:67], v[112:115], v[144:147], v[64:67]
    v_mfma_f32_16x16x32_bf16 v[68:71], v[112:115], v[148:151], v[68:71]
    v_mfma_f32_16x16x32_bf16 v[72:75], v[116:119], v[136:139], v[72:75]
    v_mfma_f32_16x16x32_bf16 v[76:79], v[116:119], v[140:143], v[76:79]
    v_mfma_f32_16x16x32_bf16 v[80:83], v[116:119], v[144:147], v[80:83]
    v_mfma_f32_16x16x32_bf16 v[84:87], v[116:119], v[148:151], v[84:87]
    s_waitcnt lgkmcnt(0)
    s_barrier
.p2align 3
    v_mfma_f32_16x16x32_bf16 v[24:27], v[120:123], v[152:155], v[24:27]
    ds_read_b64_tr_b16 v[104:105], v8 offset:0
    v_mfma_f32_16x16x32_bf16 v[28:31], v[120:123], v[156:159], v[28:31]
    ds_read_b64_tr_b16 v[106:107], v8 offset:1024
    v_mfma_f32_16x16x32_bf16 v[32:35], v[120:123], v[160:163], v[32:35]
    ds_read_b128 v[136:139], v2 offset:0
    v_mfma_f32_16x16x32_bf16 v[36:39], v[120:123], v[164:167], v[36:39]
    ds_read_b128 v[140:143], v2 offset:2048
    v_mfma_f32_16x16x32_bf16 v[88:91], v[120:123], v[20:23], v[88:91]
    ds_read_b128 v[144:147], v2 offset:4096
    v_mfma_f32_16x16x32_bf16 v[40:43], v[124:127], v[152:155], v[40:43]
    ds_read_b128 v[148:151], v2 offset:6144
    v_mfma_f32_16x16x32_bf16 v[44:47], v[124:127], v[156:159], v[44:47]
    ds_read_b64_tr_b16 v[108:109], v9 offset:0
    v_mfma_f32_16x16x32_bf16 v[48:51], v[124:127], v[160:163], v[48:51]
    ds_read_b64_tr_b16 v[110:111], v9 offset:1024
    v_mfma_f32_16x16x32_bf16 v[52:55], v[124:127], v[164:167], v[52:55]
    ds_read_b64_tr_b16 v[112:113], v10 offset:0
    v_mfma_f32_16x16x32_bf16 v[92:95], v[124:127], v[20:23], v[92:95]
    ds_read_b64_tr_b16 v[114:115], v10 offset:1024
    v_mfma_f32_16x16x32_bf16 v[56:59], v[128:131], v[152:155], v[56:59]
    ds_read_b64_tr_b16 v[116:117], v11 offset:0
    v_mfma_f32_16x16x32_bf16 v[60:63], v[128:131], v[156:159], v[60:63]
    ds_read_b64_tr_b16 v[118:119], v11 offset:1024
    v_mfma_f32_16x16x32_bf16 v[64:67], v[128:131], v[160:163], v[64:67]
    v_mfma_f32_16x16x32_bf16 v[68:71], v[128:131], v[164:167], v[68:71]
    v_mfma_f32_16x16x32_bf16 v[72:75], v[132:135], v[152:155], v[72:75]
    v_mfma_f32_16x16x32_bf16 v[76:79], v[132:135], v[156:159], v[76:79]
    v_mfma_f32_16x16x32_bf16 v[80:83], v[132:135], v[160:163], v[80:83]
    v_mfma_f32_16x16x32_bf16 v[84:87], v[132:135], v[164:167], v[84:87]
    s_waitcnt lgkmcnt(0)
.p2align 3
    v_mfma_f32_16x16x32_bf16 v[24:27], v[104:107], v[136:139], v[24:27]
    ds_read_b64_tr_b16 v[120:121], v8 offset:8192
    v_mfma_f32_16x16x32_bf16 v[28:31], v[104:107], v[140:143], v[28:31]
    ds_read_b64_tr_b16 v[122:123], v8 offset:9216
    v_mfma_f32_16x16x32_bf16 v[32:35], v[104:107], v[144:147], v[32:35]
    ds_read_b128 v[152:155], v3 offset:0
    v_mfma_f32_16x16x32_bf16 v[36:39], v[104:107], v[148:151], v[36:39]
    ds_read_b128 v[156:159], v3 offset:2048
    v_mfma_f32_16x16x32_bf16 v[88:91], v[104:107], v[20:23], v[88:91]
    ds_read_b128 v[160:163], v3 offset:4096
    v_mfma_f32_16x16x32_bf16 v[40:43], v[108:111], v[136:139], v[40:43]
    ds_read_b128 v[164:167], v3 offset:6144
    v_mfma_f32_16x16x32_bf16 v[44:47], v[108:111], v[140:143], v[44:47]
    ds_read_b64_tr_b16 v[124:125], v9 offset:8192
    v_mfma_f32_16x16x32_bf16 v[48:51], v[108:111], v[144:147], v[48:51]
    ds_read_b64_tr_b16 v[126:127], v9 offset:9216
    v_mfma_f32_16x16x32_bf16 v[52:55], v[108:111], v[148:151], v[52:55]
    ds_read_b64_tr_b16 v[128:129], v10 offset:8192
    v_mfma_f32_16x16x32_bf16 v[92:95], v[108:111], v[20:23], v[92:95]
    ds_read_b64_tr_b16 v[130:131], v10 offset:9216
    v_mfma_f32_16x16x32_bf16 v[56:59], v[112:115], v[136:139], v[56:59]
    ds_read_b64_tr_b16 v[132:133], v11 offset:8192
    v_mfma_f32_16x16x32_bf16 v[60:63], v[112:115], v[140:143], v[60:63]
    ds_read_b64_tr_b16 v[134:135], v11 offset:9216
    v_mfma_f32_16x16x32_bf16 v[64:67], v[112:115], v[144:147], v[64:67]
    v_mfma_f32_16x16x32_bf16 v[68:71], v[112:115], v[148:151], v[68:71]
    v_mfma_f32_16x16x32_bf16 v[72:75], v[116:119], v[136:139], v[72:75]
    v_mfma_f32_16x16x32_bf16 v[76:79], v[116:119], v[140:143], v[76:79]
    v_mfma_f32_16x16x32_bf16 v[80:83], v[116:119], v[144:147], v[80:83]
    v_mfma_f32_16x16x32_bf16 v[84:87], v[116:119], v[148:151], v[84:87]
    s_waitcnt lgkmcnt(0)
    s_barrier
.p2align 3
    v_mfma_f32_16x16x32_bf16 v[24:27], v[120:123], v[152:155], v[24:27]
    ds_read_b64_tr_b16 v[104:105], v8 offset:32768
    v_mfma_f32_16x16x32_bf16 v[28:31], v[120:123], v[156:159], v[28:31]
    ds_read_b64_tr_b16 v[106:107], v8 offset:33792
    v_mfma_f32_16x16x32_bf16 v[32:35], v[120:123], v[160:163], v[32:35]
    ds_read_b128 v[136:139], v2 offset:32768
    v_mfma_f32_16x16x32_bf16 v[36:39], v[120:123], v[164:167], v[36:39]
    ds_read_b128 v[140:143], v2 offset:34816
    v_mfma_f32_16x16x32_bf16 v[88:91], v[120:123], v[20:23], v[88:91]
    ds_read_b128 v[144:147], v2 offset:36864
    v_mfma_f32_16x16x32_bf16 v[40:43], v[124:127], v[152:155], v[40:43]
    ds_read_b128 v[148:151], v2 offset:38912
    v_mfma_f32_16x16x32_bf16 v[44:47], v[124:127], v[156:159], v[44:47]
    ds_read_b64_tr_b16 v[108:109], v9 offset:32768
    v_mfma_f32_16x16x32_bf16 v[48:51], v[124:127], v[160:163], v[48:51]
    ds_read_b64_tr_b16 v[110:111], v9 offset:33792
    v_mfma_f32_16x16x32_bf16 v[52:55], v[124:127], v[164:167], v[52:55]
    ds_read_b64_tr_b16 v[112:113], v10 offset:32768
    v_mfma_f32_16x16x32_bf16 v[92:95], v[124:127], v[20:23], v[92:95]
    ds_read_b64_tr_b16 v[114:115], v10 offset:33792
    v_mfma_f32_16x16x32_bf16 v[56:59], v[128:131], v[152:155], v[56:59]
    ds_read_b64_tr_b16 v[116:117], v11 offset:32768
    v_mfma_f32_16x16x32_bf16 v[60:63], v[128:131], v[156:159], v[60:63]
    ds_read_b64_tr_b16 v[118:119], v11 offset:33792
    v_mfma_f32_16x16x32_bf16 v[64:67], v[128:131], v[160:163], v[64:67]
    v_mfma_f32_16x16x32_bf16 v[68:71], v[128:131], v[164:167], v[68:71]
    v_mfma_f32_16x16x32_bf16 v[72:75], v[132:135], v[152:155], v[72:75]
    v_mfma_f32_16x16x32_bf16 v[76:79], v[132:135], v[156:159], v[76:79]
    v_mfma_f32_16x16x32_bf16 v[80:83], v[132:135], v[160:163], v[80:83]
    v_mfma_f32_16x16x32_bf16 v[84:87], v[132:135], v[164:167], v[84:87]
    s_waitcnt lgkmcnt(0)
.p2align 3
    v_mfma_f32_16x16x32_bf16 v[24:27], v[104:107], v[136:139], v[24:27]
    ds_read_b64_tr_b16 v[120:121], v8 offset:40960
    v_mfma_f32_16x16x32_bf16 v[28:31], v[104:107], v[140:143], v[28:31]
    ds_read_b64_tr_b16 v[122:123], v8 offset:41984
    v_mfma_f32_16x16x32_bf16 v[32:35], v[104:107], v[144:147], v[32:35]
    ds_read_b128 v[152:155], v3 offset:32768
    v_mfma_f32_16x16x32_bf16 v[36:39], v[104:107], v[148:151], v[36:39]
    ds_read_b128 v[156:159], v3 offset:34816
    v_mfma_f32_16x16x32_bf16 v[88:91], v[104:107], v[20:23], v[88:91]
    ds_read_b128 v[160:163], v3 offset:36864
    v_mfma_f32_16x16x32_bf16 v[40:43], v[108:111], v[136:139], v[40:43]
    ds_read_b128 v[164:167], v3 offset:38912
    v_mfma_f32_16x16x32_bf16 v[44:47], v[108:111], v[140:143], v[44:47]
    ds_read_b64_tr_b16 v[124:125], v9 offset:40960
    v_mfma_f32_16x16x32_bf16 v[48:51], v[108:111], v[144:147], v[48:51]
    ds_read_b64_tr_b16 v[126:127], v9 offset:41984
    v_mfma_f32_16x16x32_bf16 v[52:55], v[108:111], v[148:151], v[52:55]
    ds_read_b64_tr_b16 v[128:129], v10 offset:40960
    v_mfma_f32_16x16x32_bf16 v[92:95], v[108:111], v[20:23], v[92:95]
    ds_read_b64_tr_b16 v[130:131], v10 offset:41984
    v_mfma_f32_16x16x32_bf16 v[56:59], v[112:115], v[136:139], v[56:59]
    ds_read_b64_tr_b16 v[132:133], v11 offset:40960
    v_mfma_f32_16x16x32_bf16 v[60:63], v[112:115], v[140:143], v[60:63]
    ds_read_b64_tr_b16 v[134:135], v11 offset:41984
    v_mfma_f32_16x16x32_bf16 v[64:67], v[112:115], v[144:147], v[64:67]
    v_mfma_f32_16x16x32_bf16 v[68:71], v[112:115], v[148:151], v[68:71]
    v_mfma_f32_16x16x32_bf16 v[72:75], v[116:119], v[136:139], v[72:75]
    v_mfma_f32_16x16x32_bf16 v[76:79], v[116:119], v[140:143], v[76:79]
    v_mfma_f32_16x16x32_bf16 v[80:83], v[116:119], v[144:147], v[80:83]
    v_mfma_f32_16x16x32_bf16 v[84:87], v[116:119], v[148:151], v[84:87]
    s_waitcnt lgkmcnt(0)
    s_barrier
.p2align 3
    v_mfma_f32_16x16x32_bf16 v[24:27], v[120:123], v[152:155], v[24:27]
    ds_read_b64_tr_b16 v[104:105], v12 offset:0
    v_mfma_f32_16x16x32_bf16 v[28:31], v[120:123], v[156:159], v[28:31]
    ds_read_b64_tr_b16 v[106:107], v12 offset:1024
    v_mfma_f32_16x16x32_bf16 v[32:35], v[120:123], v[160:163], v[32:35]
    ds_read_b128 v[136:139], v4 offset:0
    v_mfma_f32_16x16x32_bf16 v[36:39], v[120:123], v[164:167], v[36:39]
    ds_read_b128 v[140:143], v4 offset:2048
    v_mfma_f32_16x16x32_bf16 v[88:91], v[120:123], v[20:23], v[88:91]
    ds_read_b128 v[144:147], v4 offset:4096
    v_mfma_f32_16x16x32_bf16 v[40:43], v[124:127], v[152:155], v[40:43]
    ds_read_b128 v[148:151], v4 offset:6144
    v_mfma_f32_16x16x32_bf16 v[44:47], v[124:127], v[156:159], v[44:47]
    ds_read_b64_tr_b16 v[108:109], v13 offset:0
    v_mfma_f32_16x16x32_bf16 v[48:51], v[124:127], v[160:163], v[48:51]
    ds_read_b64_tr_b16 v[110:111], v13 offset:1024
    v_mfma_f32_16x16x32_bf16 v[52:55], v[124:127], v[164:167], v[52:55]
    ds_read_b64_tr_b16 v[112:113], v14 offset:0
    v_mfma_f32_16x16x32_bf16 v[92:95], v[124:127], v[20:23], v[92:95]
    ds_read_b64_tr_b16 v[114:115], v14 offset:1024
    v_mfma_f32_16x16x32_bf16 v[56:59], v[128:131], v[152:155], v[56:59]
    ds_read_b64_tr_b16 v[116:117], v15 offset:0
    v_mfma_f32_16x16x32_bf16 v[60:63], v[128:131], v[156:159], v[60:63]
    ds_read_b64_tr_b16 v[118:119], v15 offset:1024
    v_mfma_f32_16x16x32_bf16 v[64:67], v[128:131], v[160:163], v[64:67]
    v_mfma_f32_16x16x32_bf16 v[68:71], v[128:131], v[164:167], v[68:71]
    v_mfma_f32_16x16x32_bf16 v[72:75], v[132:135], v[152:155], v[72:75]
    v_mfma_f32_16x16x32_bf16 v[76:79], v[132:135], v[156:159], v[76:79]
    v_mfma_f32_16x16x32_bf16 v[80:83], v[132:135], v[160:163], v[80:83]
    v_mfma_f32_16x16x32_bf16 v[84:87], v[132:135], v[164:167], v[84:87]
    s_waitcnt vmcnt(0)
    s_mul_i32 s30, s50, 80
    s_lshl_b32 s31, s51, 2
    s_add_u32 s30, s30, s31
    v_mov_b32 v230, 15745024
    v_mov_b32 v231, s60
    s_mov_b64 s[62:63], exec
    s_mov_b64 exec, 1
    buffer_store_dword v231, v230, s[16:19], s30 offen sc1
    s_mov_b64 exec, s[62:63]
    s_waitcnt lgkmcnt(0)
.p2align 3
    v_mfma_f32_16x16x32_bf16 v[24:27], v[104:107], v[136:139], v[24:27]
    ds_read_b64_tr_b16 v[120:121], v12 offset:8192
    v_mfma_f32_16x16x32_bf16 v[28:31], v[104:107], v[140:143], v[28:31]
    ds_read_b64_tr_b16 v[122:123], v12 offset:9216
    v_mfma_f32_16x16x32_bf16 v[32:35], v[104:107], v[144:147], v[32:35]
    ds_read_b128 v[152:155], v5 offset:0
    v_mfma_f32_16x16x32_bf16 v[36:39], v[104:107], v[148:151], v[36:39]
    ds_read_b128 v[156:159], v5 offset:2048
    v_mfma_f32_16x16x32_bf16 v[88:91], v[104:107], v[20:23], v[88:91]
    ds_read_b128 v[160:163], v5 offset:4096
    v_mfma_f32_16x16x32_bf16 v[40:43], v[108:111], v[136:139], v[40:43]
    ds_read_b128 v[164:167], v5 offset:6144
    v_mfma_f32_16x16x32_bf16 v[44:47], v[108:111], v[140:143], v[44:47]
    ds_read_b64_tr_b16 v[124:125], v13 offset:8192
    v_mfma_f32_16x16x32_bf16 v[48:51], v[108:111], v[144:147], v[48:51]
    ds_read_b64_tr_b16 v[126:127], v13 offset:9216
    v_mfma_f32_16x16x32_bf16 v[52:55], v[108:111], v[148:151], v[52:55]
    ds_read_b64_tr_b16 v[128:129], v14 offset:8192
    v_mfma_f32_16x16x32_bf16 v[92:95], v[108:111], v[20:23], v[92:95]
    ds_read_b64_tr_b16 v[130:131], v14 offset:9216
    v_mfma_f32_16x16x32_bf16 v[56:59], v[112:115], v[136:139], v[56:59]
    ds_read_b64_tr_b16 v[132:133], v15 offset:8192
    v_mfma_f32_16x16x32_bf16 v[60:63], v[112:115], v[140:143], v[60:63]
    ds_read_b64_tr_b16 v[134:135], v15 offset:9216
    v_mfma_f32_16x16x32_bf16 v[64:67], v[112:115], v[144:147], v[64:67]
    v_mfma_f32_16x16x32_bf16 v[68:71], v[112:115], v[148:151], v[68:71]
    v_mfma_f32_16x16x32_bf16 v[72:75], v[116:119], v[136:139], v[72:75]
    v_mfma_f32_16x16x32_bf16 v[76:79], v[116:119], v[140:143], v[76:79]
    v_mfma_f32_16x16x32_bf16 v[80:83], v[116:119], v[144:147], v[80:83]
    v_mfma_f32_16x16x32_bf16 v[84:87], v[116:119], v[148:151], v[84:87]
    v_and_b32 v17, 15, v1
    s_lshl_b32 s30, s38, 6
    s_add_u32 s30, s29, s30
    v_add_u32 v16, s30, v17
    v_lshlrev_b32 v16, 4, v16
    v_add_u32 v16, 2752512, v16
    buffer_load_dwordx4 v[176:179], v16, s[16:19], 0 offen offset:0 sc1
    buffer_load_dwordx4 v[180:183], v16, s[16:19], 0 offen offset:256 sc1
    buffer_load_dwordx4 v[184:187], v16, s[16:19], 0 offen offset:512 sc1
    buffer_load_dwordx4 v[188:191], v16, s[16:19], 0 offen offset:768 sc1
    s_waitcnt lgkmcnt(0)
    s_barrier
.p2align 3
    v_mfma_f32_16x16x32_bf16 v[24:27], v[120:123], v[152:155], v[24:27]
    ds_read_b64_tr_b16 v[104:105], v8 offset:0
    v_mfma_f32_16x16x32_bf16 v[28:31], v[120:123], v[156:159], v[28:31]
    ds_read_b64_tr_b16 v[106:107], v8 offset:1024
    v_mfma_f32_16x16x32_bf16 v[32:35], v[120:123], v[160:163], v[32:35]
    ds_read_b128 v[136:139], v2 offset:0
    v_mfma_f32_16x16x32_bf16 v[36:39], v[120:123], v[164:167], v[36:39]
    ds_read_b128 v[140:143], v2 offset:2048
    v_mfma_f32_16x16x32_bf16 v[88:91], v[120:123], v[20:23], v[88:91]
    ds_read_b128 v[144:147], v2 offset:4096
    v_mfma_f32_16x16x32_bf16 v[40:43], v[124:127], v[152:155], v[40:43]
    ds_read_b128 v[148:151], v2 offset:6144
    v_mfma_f32_16x16x32_bf16 v[44:47], v[124:127], v[156:159], v[44:47]
    ds_read_b64_tr_b16 v[108:109], v9 offset:0
    v_mfma_f32_16x16x32_bf16 v[48:51], v[124:127], v[160:163], v[48:51]
    ds_read_b64_tr_b16 v[110:111], v9 offset:1024
    v_mfma_f32_16x16x32_bf16 v[52:55], v[124:127], v[164:167], v[52:55]
    ds_read_b64_tr_b16 v[112:113], v10 offset:0
    v_mfma_f32_16x16x32_bf16 v[92:95], v[124:127], v[20:23], v[92:95]
    ds_read_b64_tr_b16 v[114:115], v10 offset:1024
    v_mfma_f32_16x16x32_bf16 v[56:59], v[128:131], v[152:155], v[56:59]
    ds_read_b64_tr_b16 v[116:117], v11 offset:0
    v_mfma_f32_16x16x32_bf16 v[60:63], v[128:131], v[156:159], v[60:63]
    ds_read_b64_tr_b16 v[118:119], v11 offset:1024
    v_mfma_f32_16x16x32_bf16 v[64:67], v[128:131], v[160:163], v[64:67]
    v_mfma_f32_16x16x32_bf16 v[68:71], v[128:131], v[164:167], v[68:71]
    v_mfma_f32_16x16x32_bf16 v[72:75], v[132:135], v[152:155], v[72:75]
    v_mfma_f32_16x16x32_bf16 v[76:79], v[132:135], v[156:159], v[76:79]
    v_mfma_f32_16x16x32_bf16 v[80:83], v[132:135], v[160:163], v[80:83]
    v_mfma_f32_16x16x32_bf16 v[84:87], v[132:135], v[164:167], v[84:87]
    s_waitcnt lgkmcnt(0)
.p2align 3
    v_mfma_f32_16x16x32_bf16 v[24:27], v[104:107], v[136:139], v[24:27]
    ds_read_b64_tr_b16 v[120:121], v8 offset:8192
    v_mfma_f32_16x16x32_bf16 v[28:31], v[104:107], v[140:143], v[28:31]
    ds_read_b64_tr_b16 v[122:123], v8 offset:9216
    v_mfma_f32_16x16x32_bf16 v[32:35], v[104:107], v[144:147], v[32:35]
    ds_read_b128 v[152:155], v3 offset:0
    v_mfma_f32_16x16x32_bf16 v[36:39], v[104:107], v[148:151], v[36:39]
    ds_read_b128 v[156:159], v3 offset:2048
    v_mfma_f32_16x16x32_bf16 v[88:91], v[104:107], v[20:23], v[88:91]
    ds_read_b128 v[160:163], v3 offset:4096
    v_mfma_f32_16x16x32_bf16 v[40:43], v[108:111], v[136:139], v[40:43]
    ds_read_b128 v[164:167], v3 offset:6144
    v_mfma_f32_16x16x32_bf16 v[44:47], v[108:111], v[140:143], v[44:47]
    ds_read_b64_tr_b16 v[124:125], v9 offset:8192
    v_mfma_f32_16x16x32_bf16 v[48:51], v[108:111], v[144:147], v[48:51]
    ds_read_b64_tr_b16 v[126:127], v9 offset:9216
    v_mfma_f32_16x16x32_bf16 v[52:55], v[108:111], v[148:151], v[52:55]
    ds_read_b64_tr_b16 v[128:129], v10 offset:8192
    v_mfma_f32_16x16x32_bf16 v[92:95], v[108:111], v[20:23], v[92:95]
    ds_read_b64_tr_b16 v[130:131], v10 offset:9216
    v_mfma_f32_16x16x32_bf16 v[56:59], v[112:115], v[136:139], v[56:59]
    ds_read_b64_tr_b16 v[132:133], v11 offset:8192
    v_mfma_f32_16x16x32_bf16 v[60:63], v[112:115], v[140:143], v[60:63]
    ds_read_b64_tr_b16 v[134:135], v11 offset:9216
    v_mfma_f32_16x16x32_bf16 v[64:67], v[112:115], v[144:147], v[64:67]
    v_mfma_f32_16x16x32_bf16 v[68:71], v[112:115], v[148:151], v[68:71]
    v_mfma_f32_16x16x32_bf16 v[72:75], v[116:119], v[136:139], v[72:75]
    v_mfma_f32_16x16x32_bf16 v[76:79], v[116:119], v[140:143], v[76:79]
    v_mfma_f32_16x16x32_bf16 v[80:83], v[116:119], v[144:147], v[80:83]
    v_mfma_f32_16x16x32_bf16 v[84:87], v[116:119], v[148:151], v[84:87]
    s_waitcnt lgkmcnt(0)
.p2align 3
    v_mfma_f32_16x16x32_bf16 v[24:27], v[120:123], v[152:155], v[24:27]
    v_mfma_f32_16x16x32_bf16 v[28:31], v[120:123], v[156:159], v[28:31]
    v_mfma_f32_16x16x32_bf16 v[32:35], v[120:123], v[160:163], v[32:35]
    v_mfma_f32_16x16x32_bf16 v[36:39], v[120:123], v[164:167], v[36:39]
    v_mfma_f32_16x16x32_bf16 v[88:91], v[120:123], v[20:23], v[88:91]
    v_mfma_f32_16x16x32_bf16 v[40:43], v[124:127], v[152:155], v[40:43]
    v_mfma_f32_16x16x32_bf16 v[44:47], v[124:127], v[156:159], v[44:47]
    v_mfma_f32_16x16x32_bf16 v[48:51], v[124:127], v[160:163], v[48:51]
    v_mfma_f32_16x16x32_bf16 v[52:55], v[124:127], v[164:167], v[52:55]
    v_mfma_f32_16x16x32_bf16 v[92:95], v[124:127], v[20:23], v[92:95]
    v_mfma_f32_16x16x32_bf16 v[56:59], v[128:131], v[152:155], v[56:59]
    v_mfma_f32_16x16x32_bf16 v[60:63], v[128:131], v[156:159], v[60:63]
    v_mfma_f32_16x16x32_bf16 v[64:67], v[128:131], v[160:163], v[64:67]
    v_mfma_f32_16x16x32_bf16 v[68:71], v[128:131], v[164:167], v[68:71]
    v_mfma_f32_16x16x32_bf16 v[72:75], v[132:135], v[152:155], v[72:75]
    v_mfma_f32_16x16x32_bf16 v[76:79], v[132:135], v[156:159], v[76:79]
    v_mfma_f32_16x16x32_bf16 v[80:83], v[132:135], v[160:163], v[80:83]
    v_mfma_f32_16x16x32_bf16 v[84:87], v[132:135], v[164:167], v[84:87]
    v_and_b32 v17, 15, v1
    v_lshrrev_b32 v18, 4, v1
    v_lshlrev_b32 v18, 4, v18
    s_lshl_b32 s30, s37, 2
    s_lshl_b32 s31, s38, 1
    s_add_u32 s30, s30, s31
    s_lshl_b32 s30, s30, 6
    s_add_u32 s30, s30, 32768
    v_add_u32 v19, s30, v18
    v_cmp_eq_u32 vcc, 0, v17
    s_nop 3
    s_and_saveexec_b64 s[30:31], vcc
    ds_write_b128 v19, v[88:91]
    ds_write_b128 v19, v[92:95] offset:64
    s_mov_b64 exec, s[30:31]
    s_waitcnt lgkmcnt(0)
    s_barrier
    s_waitcnt vmcnt(0)
    s_mov_b32 s61, 0
    s_branch g1_stat_cmp
g1_stat_chk:
    s_waitcnt vmcnt(0)
g1_stat_cmp:
    v_cmp_ne_u32 vcc, s60, v178
    v_cmp_ne_u32 s[58:59], s60, v182
    s_nop 3
    s_or_b64 vcc, vcc, s[58:59]
    v_cmp_ne_u32 s[58:59], s60, v186
    s_nop 3
    s_or_b64 vcc, vcc, s[58:59]
    v_cmp_ne_u32 s[58:59], s60, v190
    s_nop 3
    s_or_b64 vcc, vcc, s[58:59]
    s_cbranch_vccz g1_stat_ok
    s_sleep 1
    buffer_load_dwordx4 v[176:179], v16, s[16:19], 0 offen offset:0 sc1
    buffer_load_dwordx4 v[180:183], v16, s[16:19], 0 offen offset:256 sc1
    buffer_load_dwordx4 v[184:187], v16, s[16:19], 0 offen offset:512 sc1
    buffer_load_dwordx4 v[188:191], v16, s[16:19], 0 offen offset:768 sc1
    s_add_u32 s61, s61, 1
    s_cmp_lt_u32 s61, 0x8000
    s_cbranch_scc1 g1_stat_chk
g1_stat_ok:
    s_lshl_b32 s31, s38, 1
    s_add_u32 s31, s31, 0
    s_and_b32 s31, s31, 3
    s_lshl_b32 s33, s37, 2
    s_add_u32 s31, s31, s33
    s_lshl_b32 s31, s31, 6
    s_add_u32 s31, s31, 32768
    v_add_u32 v19, s31, v18
    ds_read_b128 v[104:107], v19
    s_lshl_b32 s31, s38, 1
    s_add_u32 s31, s31, 1
    s_and_b32 s31, s31, 3
    s_lshl_b32 s33, s37, 2
    s_add_u32 s31, s31, s33
    s_lshl_b32 s31, s31, 6
    s_add_u32 s31, s31, 32768
    v_add_u32 v19, s31, v18
    ds_read_b128 v[108:111], v19
    s_lshl_b32 s31, s38, 1
    s_add_u32 s31, s31, 2
    s_and_b32 s31, s31, 3
    s_lshl_b32 s33, s37, 2
    s_add_u32 s31, s31, s33
    s_lshl_b32 s31, s31, 6
    s_add_u32 s31, s31, 32768
    v_add_u32 v19, s31, v18
    ds_read_b128 v[112:115], v19
    s_lshl_b32 s31, s38, 1
    s_add_u32 s31, s31, 3
    s_and_b32 s31, s31, 3
    s_lshl_b32 s33, s37, 2
    s_add_u32 s31, s31, s33
    s_lshl_b32 s31, s31, 6
    s_add_u32 s31, s31, 32768
    v_add_u32 v19, s31, v18
    ds_read_b128 v[116:119], v19
    v_lshlrev_b32 v120, 16, v168
    v_and_b32 v121, 0xffff0000, v168
    v_lshlrev_b32 v122, 16, v169
    v_and_b32 v123, 0xffff0000, v169
    v_lshlrev_b32 v124, 16, v170
    v_and_b32 v125, 0xffff0000, v170
    v_lshlrev_b32 v126, 16, v171
    v_and_b32 v127, 0xffff0000, v171
    v_lshlrev_b32 v128, 16, v172
    v_and_b32 v129, 0xffff0000, v172
    v_lshlrev_b32 v130, 16, v173
    v_and_b32 v131, 0xffff0000, v173
    v_lshlrev_b32 v132, 16, v174
    v_and_b32 v133, 0xffff0000, v174
    v_lshlrev_b32 v134, 16, v175
    v_and_b32 v135, 0xffff0000, v175
    v_mov_b32 v136, 0xc0135761
    v_mov_b32 v137, 0xbdd2d3e8
    v_mov_b32 v138, 1.0
    v_lshlrev_b32 v17, 4, v1
    s_lshl_b32 s30, s42, 3
    s_lshl_b32 s31, s38, 2
    s_add_u32 s30, s30, s31
    s_mul_i32 s30, s30, 54
    s_lshl_b32 s31, s41, 2
    s_add_u32 s30, s30, s31
    s_lshl_b32 s31, s37, 1
    s_add_u32 s30, s30, s31
    s_lshl_b32 s30, s30, 10
    s_add_u32 s30, s30, 5242880
    s_lshl_b32 s31, s38, 10
    s_add_u32 s33, s30, s31
    s_xor_b32 s31, s31, 1024
    s_add_u32 s34, s30, s31
    s_waitcnt lgkmcnt(0)
    s_cmp_eq_u32 s41, 13
    s_cselect_b32 s30, s37, 0
    s_cmp_eq_u32 s30, 1
    s_cbranch_scc1 g1_stored
    v_pk_fma_f32 v[140:141], v[104:105], v[176:177], v[120:121] op_sel:[0,1,0] op_sel_hi:[1,1,1] neg_lo:[0,1,0] neg_hi:[0,1,0]
    v_pk_fma_f32 v[142:143], v[106:107], v[176:177], v[122:123] op_sel:[0,1,0] op_sel_hi:[1,1,1] neg_lo:[0,1,0] neg_hi:[0,1,0]
    v_pk_fma_f32 v[144:145], v[108:109], v[176:177], v[124:125] op_sel:[0,1,0] op_sel_hi:[1,1,1] neg_lo:[0,1,0] neg_hi:[0,1,0]
    v_pk_fma_f32 v[146:147], v[110:111], v[176:177], v[126:127] op_sel:[0,1,0] op_sel_hi:[1,1,1] neg_lo:[0,1,0] neg_hi:[0,1,0]
    v_pk_fma_f32 v[148:149], v[104:105], v[180:181], v[120:121] op_sel:[0,1,0] op_sel_hi:[1,1,1] neg_lo:[0,1,0] neg_hi:[0,1,0]
    v_pk_fma_f32 v[150:151], v[106:107], v[180:181], v[122:123] op_sel:[0,1,0] op_sel_hi:[1,1,1] neg_lo:[0,1,0] neg_hi:[0,1,0]
    v_pk_fma_f32 v[152:153], v[108:109], v[180:181], v[124:125] op_sel:[0,1,0] op_sel_hi:[1,1,1] neg_lo:[0,1,0] neg_hi:[0,1,0]
    v_pk_fma_f32 v[154:155], v[110:111], v[180:181], v[126:127] op_sel:[0,1,0] op_sel_hi:[1,1,1] neg_lo:[0,1,0] neg_hi:[0,1,0]
    v_pk_fma_f32 v[24:25], v[24:25], v[176:177], v[140:141] op_sel:[0,0,0] op_sel_hi:[1,0,1]
    v_pk_fma_f32 v[26:27], v[26:27], v[176:177], v[142:143] op_sel:[0,0,0] op_sel_hi:[1,0,1]
    v_pk_fma_f32 v[40:41], v[40:41], v[176:177], v[144:145] op_sel:[0,0,0] op_sel_hi:[1,0,1]
    v_pk_fma_f32 v[42:43], v[42:43], v[176:177], v[146:147] op_sel:[0,0,0] op_sel_hi:[1,0,1]
    v_pk_fma_f32 v[28:29], v[28:29], v[180:181], v[148:149] op_sel:[0,0,0] op_sel_hi:[1,0,1]
    v_pk_fma_f32 v[30:31], v[30:31], v[180:181], v[150:151] op_sel:[0,0,0] op_sel_hi:[1,0,1]
    v_pk_fma_f32 v[44:45], v[44:45], v[180:181], v[152:153] op_sel:[0,0,0] op_sel_hi:[1,0,1]
    v_pk_fma_f32 v[46:47], v[46:47], v[180:181], v[154:155] op_sel:[0,0,0] op_sel_hi:[1,0,1]
    v_pk_mul_f32 v[140:141], v[24:25], v[24:25]
    v_pk_mul_f32 v[142:143], v[26:27], v[26:27]
    v_pk_mul_f32 v[144:145], v[40:41], v[40:41]
    v_pk_mul_f32 v[146:147], v[42:43], v[42:43]
    v_pk_mul_f32 v[148:149], v[28:29], v[28:29]
    v_pk_mul_f32 v[150:151], v[30:31], v[30:31]
    v_pk_mul_f32 v[152:153], v[44:45], v[44:45]
    v_pk_mul_f32 v[154:155], v[46:47], v[46:47]
    v_pk_fma_f32 v[140:141], v[140:141], v[136:137], v[136:137] op_sel:[0,1,0] op_sel_hi:[1,1,0]
    v_pk_fma_f32 v[142:143], v[142:143], v[136:137], v[136:137] op_sel:[0,1,0] op_sel_hi:[1,1,0]
    v_pk_fma_f32 v[144:145], v[144:145], v[136:137], v[136:137] op_sel:[0,1,0] op_sel_hi:[1,1,0]
    v_pk_fma_f32 v[146:147], v[146:147], v[136:137], v[136:137] op_sel:[0,1,0] op_sel_hi:[1,1,0]
    v_pk_fma_f32 v[148:149], v[148:149], v[136:137], v[136:137] op_sel:[0,1,0] op_sel_hi:[1,1,0]
    v_pk_fma_f32 v[150:151], v[150:151], v[136:137], v[136:137] op_sel:[0,1,0] op_sel_hi:[1,1,0]
    v_pk_fma_f32 v[152:153], v[152:153], v[136:137], v[136:137] op_sel:[0,1,0] op_sel_hi:[1,1,0]
    v_pk_fma_f32 v[154:155], v[154:155], v[136:137], v[136:137] op_sel:[0,1,0] op_sel_hi:[1,1,0]
    v_pk_mul_f32 v[140:141], v[140:141], v[24:25]
    v_pk_mul_f32 v[142:143], v[142:143], v[26:27]
    v_pk_mul_f32 v[144:145], v[144:145], v[40:41]
    v_pk_mul_f32 v[146:147], v[146:147], v[42:43]
    v_pk_mul_f32 v[148:149], v[148:149], v[28:29]
    v_pk_mul_f32 v[150:151], v[150:151], v[30:31]
    v_pk_mul_f32 v[152:153], v[152:153], v[44:45]
    v_pk_mul_f32 v[154:155], v[154:155], v[46:47]
    v_exp_f32 v140, v140
    v_exp_f32 v142, v142
    v_exp_f32 v144, v144
    v_exp_f32 v146, v146
    v_exp_f32 v148, v148
    v_exp_f32 v150, v150
    v_exp_f32 v152, v152
    v_exp_f32 v154, v154
    v_exp_f32 v141, v141
    v_exp_f32 v143, v143
    v_exp_f32 v145, v145
    v_exp_f32 v147, v147
    v_exp_f32 v149, v149
    v_exp_f32 v151, v151
    v_exp_f32 v153, v153
    v_exp_f32 v155, v155
    v_pk_add_f32 v[140:141], v[140:141], v[138:139] op_sel_hi:[1,0]
    v_pk_add_f32 v[142:143], v[142:143], v[138:139] op_sel_hi:[1,0]
    v_pk_add_f32 v[144:145], v[144:145], v[138:139] op_sel_hi:[1,0]
    v_pk_add_f32 v[146:147], v[146:147], v[138:139] op_sel_hi:[1,0]
    v_pk_add_f32 v[148:149], v[148:149], v[138:139] op_sel_hi:[1,0]
    v_pk_add_f32 v[150:151], v[150:151], v[138:139] op_sel_hi:[1,0]
    v_pk_add_f32 v[152:153], v[152:153], v[138:139] op_sel_hi:[1,0]
    v_pk_add_f32 v[154:155], v[154:155], v[138:139] op_sel_hi:[1,0]
    v_rcp_f32 v140, v140
    v_rcp_f32 v142, v142
    v_rcp_f32 v144, v144
    v_rcp_f32 v146, v146
    v_rcp_f32 v148, v148
    v_rcp_f32 v150, v150
    v_rcp_f32 v152, v152
    v_rcp_f32 v154, v154
    v_rcp_f32 v141, v141
    v_rcp_f32 v143, v143
    v_rcp_f32 v145, v145
    v_rcp_f32 v147, v147
    v_rcp_f32 v149, v149
    v_rcp_f32 v151, v151
    v_rcp_f32 v153, v153
    v_rcp_f32 v155, v155
    v_pk_mul_f32 v[24:25], v[24:25], v[140:141]
    v_pk_mul_f32 v[26:27], v[26:27], v[142:143]
    v_pk_mul_f32 v[40:41], v[40:41], v[144:145]
    v_pk_mul_f32 v[42:43], v[42:43], v[146:147]
    v_pk_mul_f32 v[28:29], v[28:29], v[148:149]
    v_pk_mul_f32 v[30:31], v[30:31], v[150:151]
    v_pk_mul_f32 v[44:45], v[44:45], v[152:153]
    v_pk_mul_f32 v[46:47], v[46:47], v[154:155]
    v_cvt_pk_bf16_f32 v192, v24, v25
    v_cvt_pk_bf16_f32 v193, v26, v27
    v_cvt_pk_bf16_f32 v194, v40, v41
    v_cvt_pk_bf16_f32 v195, v42, v43
    v_cvt_pk_bf16_f32 v196, v28, v29
    v_cvt_pk_bf16_f32 v197, v30, v31
    v_cvt_pk_bf16_f32 v198, v44, v45
    v_cvt_pk_bf16_f32 v199, v46, v47
    s_add_u32 s31, s33, 0
    buffer_store_dwordx4 v[192:195], v17, s[16:19], s31 offen sc1
    s_add_u32 s31, s33, 55296
    buffer_store_dwordx4 v[196:199], v17, s[16:19], s31 offen sc1
    v_pk_fma_f32 v[140:141], v[104:105], v[184:185], v[120:121] op_sel:[0,1,0] op_sel_hi:[1,1,1] neg_lo:[0,1,0] neg_hi:[0,1,0]
    v_pk_fma_f32 v[142:143], v[106:107], v[184:185], v[122:123] op_sel:[0,1,0] op_sel_hi:[1,1,1] neg_lo:[0,1,0] neg_hi:[0,1,0]
    v_pk_fma_f32 v[144:145], v[108:109], v[184:185], v[124:125] op_sel:[0,1,0] op_sel_hi:[1,1,1] neg_lo:[0,1,0] neg_hi:[0,1,0]
    v_pk_fma_f32 v[146:147], v[110:111], v[184:185], v[126:127] op_sel:[0,1,0] op_sel_hi:[1,1,1] neg_lo:[0,1,0] neg_hi:[0,1,0]
    v_pk_fma_f32 v[148:149], v[104:105], v[188:189], v[120:121] op_sel:[0,1,0] op_sel_hi:[1,1,1] neg_lo:[0,1,0] neg_hi:[0,1,0]
    v_pk_fma_f32 v[150:151], v[106:107], v[188:189], v[122:123] op_sel:[0,1,0] op_sel_hi:[1,1,1] neg_lo:[0,1,0] neg_hi:[0,1,0]
    v_pk_fma_f32 v[152:153], v[108:109], v[188:189], v[124:125] op_sel:[0,1,0] op_sel_hi:[1,1,1] neg_lo:[0,1,0] neg_hi:[0,1,0]
    v_pk_fma_f32 v[154:155], v[110:111], v[188:189], v[126:127] op_sel:[0,1,0] op_sel_hi:[1,1,1] neg_lo:[0,1,0] neg_hi:[0,1,0]
    v_pk_fma_f32 v[32:33], v[32:33], v[184:185], v[140:141] op_sel:[0,0,0] op_sel_hi:[1,0,1]
    v_pk_fma_f32 v[34:35], v[34:35], v[184:185], v[142:143] op_sel:[0,0,0] op_sel_hi:[1,0,1]
    v_pk_fma_f32 v[48:49], v[48:49], v[184:185], v[144:145] op_sel:[0,0,0] op_sel_hi:[1,0,1]
    v_pk_fma_f32 v[50:51], v[50:51], v[184:185], v[146:147] op_sel:[0,0,0] op_sel_hi:[1,0,1]
    v_pk_fma_f32 v[36:37], v[36:37], v[188:189], v[148:149] op_sel:[0,0,0] op_sel_hi:[1,0,1]
    v_pk_fma_f32 v[38:39], v[38:39], v[188:189], v[150:151] op_sel:[0,0,0] op_sel_hi:[1,0,1]
    v_pk_fma_f32 v[52:53], v[52:53], v[188:189], v[152:153] op_sel:[0,0,0] op_sel_hi:[1,0,1]
    v_pk_fma_f32 v[54:55], v[54:55], v[188:189], v[154:155] op_sel:[0,0,0] op_sel_hi:[1,0,1]
    v_pk_mul_f32 v[140:141], v[32:33], v[32:33]
    v_pk_mul_f32 v[142:143], v[34:35], v[34:35]
    v_pk_mul_f32 v[144:145], v[48:49], v[48:49]
    v_pk_mul_f32 v[146:147], v[50:51], v[50:51]
    v_pk_mul_f32 v[148:149], v[36:37], v[36:37]
    v_pk_mul_f32 v[150:151], v[38:39], v[38:39]
    v_pk_mul_f32 v[152:153], v[52:53], v[52:53]
    v_pk_mul_f32 v[154:155], v[54:55], v[54:55]
    v_pk_fma_f32 v[140:141], v[140:141], v[136:137], v[136:137] op_sel:[0,1,0] op_sel_hi:[1,1,0]
    v_pk_fma_f32 v[142:143], v[142:143], v[136:137], v[136:137] op_sel:[0,1,0] op_sel_hi:[1,1,0]
    v_pk_fma_f32 v[144:145], v[144:145], v[136:137], v[136:137] op_sel:[0,1,0] op_sel_hi:[1,1,0]
    v_pk_fma_f32 v[146:147], v[146:147], v[136:137], v[136:137] op_sel:[0,1,0] op_sel_hi:[1,1,0]
    v_pk_fma_f32 v[148:149], v[148:149], v[136:137], v[136:137] op_sel:[0,1,0] op_sel_hi:[1,1,0]
    v_pk_fma_f32 v[150:151], v[150:151], v[136:137], v[136:137] op_sel:[0,1,0] op_sel_hi:[1,1,0]
    v_pk_fma_f32 v[152:153], v[152:153], v[136:137], v[136:137] op_sel:[0,1,0] op_sel_hi:[1,1,0]
    v_pk_fma_f32 v[154:155], v[154:155], v[136:137], v[136:137] op_sel:[0,1,0] op_sel_hi:[1,1,0]
    v_pk_mul_f32 v[140:141], v[140:141], v[32:33]
    v_pk_mul_f32 v[142:143], v[142:143], v[34:35]
    v_pk_mul_f32 v[144:145], v[144:145], v[48:49]
    v_pk_mul_f32 v[146:147], v[146:147], v[50:51]
    v_pk_mul_f32 v[148:149], v[148:149], v[36:37]
    v_pk_mul_f32 v[150:151], v[150:151], v[38:39]
    v_pk_mul_f32 v[152:153], v[152:153], v[52:53]
    v_pk_mul_f32 v[154:155], v[154:155], v[54:55]
    v_exp_f32 v140, v140
    v_exp_f32 v142, v142
    v_exp_f32 v144, v144
    v_exp_f32 v146, v146
    v_exp_f32 v148, v148
    v_exp_f32 v150, v150
    v_exp_f32 v152, v152
    v_exp_f32 v154, v154
    v_exp_f32 v141, v141
    v_exp_f32 v143, v143
    v_exp_f32 v145, v145
    v_exp_f32 v147, v147
    v_exp_f32 v149, v149
    v_exp_f32 v151, v151
    v_exp_f32 v153, v153
    v_exp_f32 v155, v155
    v_pk_add_f32 v[140:141], v[140:141], v[138:139] op_sel_hi:[1,0]
    v_pk_add_f32 v[142:143], v[142:143], v[138:139] op_sel_hi:[1,0]
    v_pk_add_f32 v[144:145], v[144:145], v[138:139] op_sel_hi:[1,0]
    v_pk_add_f32 v[146:147], v[146:147], v[138:139] op_sel_hi:[1,0]
    v_pk_add_f32 v[148:149], v[148:149], v[138:139] op_sel_hi:[1,0]
    v_pk_add_f32 v[150:151], v[150:151], v[138:139] op_sel_hi:[1,0]
    v_pk_add_f32 v[152:153], v[152:153], v[138:139] op_sel_hi:[1,0]
    v_pk_add_f32 v[154:155], v[154:155], v[138:139] op_sel_hi:[1,0]
    v_rcp_f32 v140, v140
    v_rcp_f32 v142, v142
    v_rcp_f32 v144, v144
    v_rcp_f32 v146, v146
    v_rcp_f32 v148, v148
    v_rcp_f32 v150, v150
    v_rcp_f32 v152, v152
    v_rcp_f32 v154, v154
    v_rcp_f32 v141, v141
    v_rcp_f32 v143, v143
    v_rcp_f32 v145, v145
    v_rcp_f32 v147, v147
    v_rcp_f32 v149, v149
    v_rcp_f32 v151, v151
    v_rcp_f32 v153, v153
    v_rcp_f32 v155, v155
    v_pk_mul_f32 v[32:33], v[32:33], v[140:141]
    v_pk_mul_f32 v[34:35], v[34:35], v[142:143]
    v_pk_mul_f32 v[48:49], v[48:49], v[144:145]
    v_pk_mul_f32 v[50:51], v[50:51], v[146:147]
    v_pk_mul_f32 v[36:37], v[36:37], v[148:149]
    v_pk_mul_f32 v[38:39], v[38:39], v[150:151]
    v_pk_mul_f32 v[52:53], v[52:53], v[152:153]
    v_pk_mul_f32 v[54:55], v[54:55], v[154:155]
    v_cvt_pk_bf16_f32 v200, v32, v33
    v_cvt_pk_bf16_f32 v201, v34, v35
    v_cvt_pk_bf16_f32 v202, v48, v49
    v_cvt_pk_bf16_f32 v203, v50, v51
    v_cvt_pk_bf16_f32 v204, v36, v37
    v_cvt_pk_bf16_f32 v205, v38, v39
    v_cvt_pk_bf16_f32 v206, v52, v53
    v_cvt_pk_bf16_f32 v207, v54, v55
    s_add_u32 s31, s33, 110592
    buffer_store_dwordx4 v[200:203], v17, s[16:19], s31 offen sc1
    s_add_u32 s31, s33, 165888
    buffer_store_dwordx4 v[204:207], v17, s[16:19], s31 offen sc1
    v_pk_fma_f32 v[140:141], v[112:113], v[176:177], v[128:129] op_sel:[0,1,0] op_sel_hi:[1,1,1] neg_lo:[0,1,0] neg_hi:[0,1,0]
    v_pk_fma_f32 v[142:143], v[114:115], v[176:177], v[130:131] op_sel:[0,1,0] op_sel_hi:[1,1,1] neg_lo:[0,1,0] neg_hi:[0,1,0]
    v_pk_fma_f32 v[144:145], v[116:117], v[176:177], v[132:133] op_sel:[0,1,0] op_sel_hi:[1,1,1] neg_lo:[0,1,0] neg_hi:[0,1,0]
    v_pk_fma_f32 v[146:147], v[118:119], v[176:177], v[134:135] op_sel:[0,1,0] op_sel_hi:[1,1,1] neg_lo:[0,1,0] neg_hi:[0,1,0]
    v_pk_fma_f32 v[148:149], v[112:113], v[180:181], v[128:129] op_sel:[0,1,0] op_sel_hi:[1,1,1] neg_lo:[0,1,0] neg_hi:[0,1,0]
    v_pk_fma_f32 v[150:151], v[114:115], v[180:181], v[130:131] op_sel:[0,1,0] op_sel_hi:[1,1,1] neg_lo:[0,1,0] neg_hi:[0,1,0]
    v_pk_fma_f32 v[152:153], v[116:117], v[180:181], v[132:133] op_sel:[0,1,0] op_sel_hi:[1,1,1] neg_lo:[0,1,0] neg_hi:[0,1,0]
    v_pk_fma_f32 v[154:155], v[118:119], v[180:181], v[134:135] op_sel:[0,1,0] op_sel_hi:[1,1,1] neg_lo:[0,1,0] neg_hi:[0,1,0]
    v_pk_fma_f32 v[56:57], v[56:57], v[176:177], v[140:141] op_sel:[0,0,0] op_sel_hi:[1,0,1]
    v_pk_fma_f32 v[58:59], v[58:59], v[176:177], v[142:143] op_sel:[0,0,0] op_sel_hi:[1,0,1]
    v_pk_fma_f32 v[72:73], v[72:73], v[176:177], v[144:145] op_sel:[0,0,0] op_sel_hi:[1,0,1]
    v_pk_fma_f32 v[74:75], v[74:75], v[176:177], v[146:147] op_sel:[0,0,0] op_sel_hi:[1,0,1]
    v_pk_fma_f32 v[60:61], v[60:61], v[180:181], v[148:149] op_sel:[0,0,0] op_sel_hi:[1,0,1]
    v_pk_fma_f32 v[62:63], v[62:63], v[180:181], v[150:151] op_sel:[0,0,0] op_sel_hi:[1,0,1]
    v_pk_fma_f32 v[76:77], v[76:77], v[180:181], v[152:153] op_sel:[0,0,0] op_sel_hi:[1,0,1]
    v_pk_fma_f32 v[78:79], v[78:79], v[180:181], v[154:155] op_sel:[0,0,0] op_sel_hi:[1,0,1]
    v_pk_mul_f32 v[140:141], v[56:57], v[56:57]
    v_pk_mul_f32 v[142:143], v[58:59], v[58:59]
    v_pk_mul_f32 v[144:145], v[72:73], v[72:73]
    v_pk_mul_f32 v[146:147], v[74:75], v[74:75]
    v_pk_mul_f32 v[148:149], v[60:61], v[60:61]
    v_pk_mul_f32 v[150:151], v[62:63], v[62:63]
    v_pk_mul_f32 v[152:153], v[76:77], v[76:77]
    v_pk_mul_f32 v[154:155], v[78:79], v[78:79]
    v_pk_fma_f32 v[140:141], v[140:141], v[136:137], v[136:137] op_sel:[0,1,0] op_sel_hi:[1,1,0]
    v_pk_fma_f32 v[142:143], v[142:143], v[136:137], v[136:137] op_sel:[0,1,0] op_sel_hi:[1,1,0]
    v_pk_fma_f32 v[144:145], v[144:145], v[136:137], v[136:137] op_sel:[0,1,0] op_sel_hi:[1,1,0]
    v_pk_fma_f32 v[146:147], v[146:147], v[136:137], v[136:137] op_sel:[0,1,0] op_sel_hi:[1,1,0]
    v_pk_fma_f32 v[148:149], v[148:149], v[136:137], v[136:137] op_sel:[0,1,0] op_sel_hi:[1,1,0]
    v_pk_fma_f32 v[150:151], v[150:151], v[136:137], v[136:137] op_sel:[0,1,0] op_sel_hi:[1,1,0]
    v_pk_fma_f32 v[152:153], v[152:153], v[136:137], v[136:137] op_sel:[0,1,0] op_sel_hi:[1,1,0]
    v_pk_fma_f32 v[154:155], v[154:155], v[136:137], v[136:137] op_sel:[0,1,0] op_sel_hi:[1,1,0]
    v_pk_mul_f32 v[140:141], v[140:141], v[56:57]
    v_pk_mul_f32 v[142:143], v[142:143], v[58:59]
    v_pk_mul_f32 v[144:145], v[144:145], v[72:73]
    v_pk_mul_f32 v[146:147], v[146:147], v[74:75]
    v_pk_mul_f32 v[148:149], v[148:149], v[60:61]
    v_pk_mul_f32 v[150:151], v[150:151], v[62:63]
    v_pk_mul_f32 v[152:153], v[152:153], v[76:77]
    v_pk_mul_f32 v[154:155], v[154:155], v[78:79]
    v_exp_f32 v140, v140
    v_exp_f32 v142, v142
    v_exp_f32 v144, v144
    v_exp_f32 v146, v146
    v_exp_f32 v148, v148
    v_exp_f32 v150, v150
    v_exp_f32 v152, v152
    v_exp_f32 v154, v154
    v_exp_f32 v141, v141
    v_exp_f32 v143, v143
    v_exp_f32 v145, v145
    v_exp_f32 v147, v147
    v_exp_f32 v149, v149
    v_exp_f32 v151, v151
    v_exp_f32 v153, v153
    v_exp_f32 v155, v155
    v_pk_add_f32 v[140:141], v[140:141], v[138:139] op_sel_hi:[1,0]
    v_pk_add_f32 v[142:143], v[142:143], v[138:139] op_sel_hi:[1,0]
    v_pk_add_f32 v[144:145], v[144:145], v[138:139] op_sel_hi:[1,0]
    v_pk_add_f32 v[146:147], v[146:147], v[138:139] op_sel_hi:[1,0]
    v_pk_add_f32 v[148:149], v[148:149], v[138:139] op_sel_hi:[1,0]
    v_pk_add_f32 v[150:151], v[150:151], v[138:139] op_sel_hi:[1,0]
    v_pk_add_f32 v[152:153], v[152:153], v[138:139] op_sel_hi:[1,0]
    v_pk_add_f32 v[154:155], v[154:155], v[138:139] op_sel_hi:[1,0]
    v_rcp_f32 v140, v140
    v_rcp_f32 v142, v142
    v_rcp_f32 v144, v144
    v_rcp_f32 v146, v146
    v_rcp_f32 v148, v148
    v_rcp_f32 v150, v150
    v_rcp_f32 v152, v152
    v_rcp_f32 v154, v154
    v_rcp_f32 v141, v141
    v_rcp_f32 v143, v143
    v_rcp_f32 v145, v145
    v_rcp_f32 v147, v147
    v_rcp_f32 v149, v149
    v_rcp_f32 v151, v151
    v_rcp_f32 v153, v153
    v_rcp_f32 v155, v155
    v_pk_mul_f32 v[56:57], v[56:57], v[140:141]
    v_pk_mul_f32 v[58:59], v[58:59], v[142:143]
    v_pk_mul_f32 v[72:73], v[72:73], v[144:145]
    v_pk_mul_f32 v[74:75], v[74:75], v[146:147]
    v_pk_mul_f32 v[60:61], v[60:61], v[148:149]
    v_pk_mul_f32 v[62:63], v[62:63], v[150:151]
    v_pk_mul_f32 v[76:77], v[76:77], v[152:153]
    v_pk_mul_f32 v[78:79], v[78:79], v[154:155]
    v_cvt_pk_bf16_f32 v208, v56, v57
    v_cvt_pk_bf16_f32 v209, v58, v59
    v_cvt_pk_bf16_f32 v210, v72, v73
    v_cvt_pk_bf16_f32 v211, v74, v75
    v_cvt_pk_bf16_f32 v212, v60, v61
    v_cvt_pk_bf16_f32 v213, v62, v63
    v_cvt_pk_bf16_f32 v214, v76, v77
    v_cvt_pk_bf16_f32 v215, v78, v79
    s_add_u32 s31, s34, 0
    buffer_store_dwordx4 v[208:211], v17, s[16:19], s31 offen sc1
    s_add_u32 s31, s34, 55296
    buffer_store_dwordx4 v[212:215], v17, s[16:19], s31 offen sc1
    v_pk_fma_f32 v[140:141], v[112:113], v[184:185], v[128:129] op_sel:[0,1,0] op_sel_hi:[1,1,1] neg_lo:[0,1,0] neg_hi:[0,1,0]
    v_pk_fma_f32 v[142:143], v[114:115], v[184:185], v[130:131] op_sel:[0,1,0] op_sel_hi:[1,1,1] neg_lo:[0,1,0] neg_hi:[0,1,0]
    v_pk_fma_f32 v[144:145], v[116:117], v[184:185], v[132:133] op_sel:[0,1,0] op_sel_hi:[1,1,1] neg_lo:[0,1,0] neg_hi:[0,1,0]
    v_pk_fma_f32 v[146:147], v[118:119], v[184:185], v[134:135] op_sel:[0,1,0] op_sel_hi:[1,1,1] neg_lo:[0,1,0] neg_hi:[0,1,0]
    v_pk_fma_f32 v[148:149], v[112:113], v[188:189], v[128:129] op_sel:[0,1,0] op_sel_hi:[1,1,1] neg_lo:[0,1,0] neg_hi:[0,1,0]
    v_pk_fma_f32 v[150:151], v[114:115], v[188:189], v[130:131] op_sel:[0,1,0] op_sel_hi:[1,1,1] neg_lo:[0,1,0] neg_hi:[0,1,0]
    v_pk_fma_f32 v[152:153], v[116:117], v[188:189], v[132:133] op_sel:[0,1,0] op_sel_hi:[1,1,1] neg_lo:[0,1,0] neg_hi:[0,1,0]
    v_pk_fma_f32 v[154:155], v[118:119], v[188:189], v[134:135] op_sel:[0,1,0] op_sel_hi:[1,1,1] neg_lo:[0,1,0] neg_hi:[0,1,0]
    v_pk_fma_f32 v[64:65], v[64:65], v[184:185], v[140:141] op_sel:[0,0,0] op_sel_hi:[1,0,1]
    v_pk_fma_f32 v[66:67], v[66:67], v[184:185], v[142:143] op_sel:[0,0,0] op_sel_hi:[1,0,1]
    v_pk_fma_f32 v[80:81], v[80:81], v[184:185], v[144:145] op_sel:[0,0,0] op_sel_hi:[1,0,1]
    v_pk_fma_f32 v[82:83], v[82:83], v[184:185], v[146:147] op_sel:[0,0,0] op_sel_hi:[1,0,1]
    v_pk_fma_f32 v[68:69], v[68:69], v[188:189], v[148:149] op_sel:[0,0,0] op_sel_hi:[1,0,1]
    v_pk_fma_f32 v[70:71], v[70:71], v[188:189], v[150:151] op_sel:[0,0,0] op_sel_hi:[1,0,1]
    v_pk_fma_f32 v[84:85], v[84:85], v[188:189], v[152:153] op_sel:[0,0,0] op_sel_hi:[1,0,1]
    v_pk_fma_f32 v[86:87], v[86:87], v[188:189], v[154:155] op_sel:[0,0,0] op_sel_hi:[1,0,1]
    v_pk_mul_f32 v[140:141], v[64:65], v[64:65]
    v_pk_mul_f32 v[142:143], v[66:67], v[66:67]
    v_pk_mul_f32 v[144:145], v[80:81], v[80:81]
    v_pk_mul_f32 v[146:147], v[82:83], v[82:83]
    v_pk_mul_f32 v[148:149], v[68:69], v[68:69]
    v_pk_mul_f32 v[150:151], v[70:71], v[70:71]
    v_pk_mul_f32 v[152:153], v[84:85], v[84:85]
    v_pk_mul_f32 v[154:155], v[86:87], v[86:87]
    v_pk_fma_f32 v[140:141], v[140:141], v[136:137], v[136:137] op_sel:[0,1,0] op_sel_hi:[1,1,0]
    v_pk_fma_f32 v[142:143], v[142:143], v[136:137], v[136:137] op_sel:[0,1,0] op_sel_hi:[1,1,0]
    v_pk_fma_f32 v[144:145], v[144:145], v[136:137], v[136:137] op_sel:[0,1,0] op_sel_hi:[1,1,0]
    v_pk_fma_f32 v[146:147], v[146:147], v[136:137], v[136:137] op_sel:[0,1,0] op_sel_hi:[1,1,0]
    v_pk_fma_f32 v[148:149], v[148:149], v[136:137], v[136:137] op_sel:[0,1,0] op_sel_hi:[1,1,0]
    v_pk_fma_f32 v[150:151], v[150:151], v[136:137], v[136:137] op_sel:[0,1,0] op_sel_hi:[1,1,0]
    v_pk_fma_f32 v[152:153], v[152:153], v[136:137], v[136:137] op_sel:[0,1,0] op_sel_hi:[1,1,0]
    v_pk_fma_f32 v[154:155], v[154:155], v[136:137], v[136:137] op_sel:[0,1,0] op_sel_hi:[1,1,0]
    v_pk_mul_f32 v[140:141], v[140:141], v[64:65]
    v_pk_mul_f32 v[142:143], v[142:143], v[66:67]
    v_pk_mul_f32 v[144:145], v[144:145], v[80:81]
    v_pk_mul_f32 v[146:147], v[146:147], v[82:83]
    v_pk_mul_f32 v[148:149], v[148:149], v[68:69]
    v_pk_mul_f32 v[150:151], v[150:151], v[70:71]
    v_pk_mul_f32 v[152:153], v[152:153], v[84:85]
    v_pk_mul_f32 v[154:155], v[154:155], v[86:87]
    v_exp_f32 v140, v140
    v_exp_f32 v142, v142
    v_exp_f32 v144, v144
    v_exp_f32 v146, v146
    v_exp_f32 v148, v148
    v_exp_f32 v150, v150
    v_exp_f32 v152, v152
    v_exp_f32 v154, v154
    v_exp_f32 v141, v141
    v_exp_f32 v143, v143
    v_exp_f32 v145, v145
    v_exp_f32 v147, v147
    v_exp_f32 v149, v149
    v_exp_f32 v151, v151
    v_exp_f32 v153, v153
    v_exp_f32 v155, v155
    v_pk_add_f32 v[140:141], v[140:141], v[138:139] op_sel_hi:[1,0]
    v_pk_add_f32 v[142:143], v[142:143], v[138:139] op_sel_hi:[1,0]
    v_pk_add_f32 v[144:145], v[144:145], v[138:139] op_sel_hi:[1,0]
    v_pk_add_f32 v[146:147], v[146:147], v[138:139] op_sel_hi:[1,0]
    v_pk_add_f32 v[148:149], v[148:149], v[138:139] op_sel_hi:[1,0]
    v_pk_add_f32 v[150:151], v[150:151], v[138:139] op_sel_hi:[1,0]
    v_pk_add_f32 v[152:153], v[152:153], v[138:139] op_sel_hi:[1,0]
    v_pk_add_f32 v[154:155], v[154:155], v[138:139] op_sel_hi:[1,0]
    v_rcp_f32 v140, v140
    v_rcp_f32 v142, v142
    v_rcp_f32 v144, v144
    v_rcp_f32 v146, v146
    v_rcp_f32 v148, v148
    v_rcp_f32 v150, v150
    v_rcp_f32 v152, v152
    v_rcp_f32 v154, v154
    v_rcp_f32 v141, v141
    v_rcp_f32 v143, v143
    v_rcp_f32 v145, v145
    v_rcp_f32 v147, v147
    v_rcp_f32 v149, v149
    v_rcp_f32 v151, v151
    v_rcp_f32 v153, v153
    v_rcp_f32 v155, v155
    v_pk_mul_f32 v[64:65], v[64:65], v[140:141]
    v_pk_mul_f32 v[66:67], v[66:67], v[142:143]
    v_pk_mul_f32 v[80:81], v[80:81], v[144:145]
    v_pk_mul_f32 v[82:83], v[82:83], v[146:147]
    v_pk_mul_f32 v[68:69], v[68:69], v[148:149]
    v_pk_mul_f32 v[70:71], v[70:71], v[150:151]
    v_pk_mul_f32 v[84:85], v[84:85], v[152:153]
    v_pk_mul_f32 v[86:87], v[86:87], v[154:155]
    v_cvt_pk_bf16_f32 v216, v64, v65
    v_cvt_pk_bf16_f32 v217, v66, v67
    v_cvt_pk_bf16_f32 v218, v80, v81
    v_cvt_pk_bf16_f32 v219, v82, v83
    v_cvt_pk_bf16_f32 v220, v68, v69
    v_cvt_pk_bf16_f32 v221, v70, v71
    v_cvt_pk_bf16_f32 v222, v84, v85
    v_cvt_pk_bf16_f32 v223, v86, v87
    s_add_u32 s31, s34, 110592
    buffer_store_dwordx4 v[216:219], v17, s[16:19], s31 offen sc1
    s_add_u32 s31, s34, 165888
    buffer_store_dwordx4 v[220:223], v17, s[16:19], s31 offen sc1
g1_stored:
    v_mov_b32 v229, 1
    ds_write_b32 v228, v229
    s_mov_b32 s27, 1
    s_branch gemm2_path
g1_loader:
    s_setprio 3
    s_sub_u32 s37, s28, 4
    v_lshrrev_b32 v17, 4, v1
    s_lshr_b32 s30, s37, 1
    s_lshl_b32 s30, s30, 3
    v_lshlrev_b32 v18, 1, v17
    v_add_u32 v18, s30, v18
    v_and_b32 v19, 15, v1
    v_xor_b32 v18, v18, v19
    v_lshlrev_b32 v18, 4, v18
    s_lshl_b32 s30, s37, 2
    v_add_u32 v17, s30, v17
    v_mul_u32_u24 v17, 3456, v17
    s_lshl_b32 s30, s41, 8
    v_add3_u32 v14, v17, v18, s30
    s_lshl_b32 s32, s37, 10
    s_lshl_b32 s29, s42, 7
    s_lshl_b32 s30, s37, 3
    s_add_u32 s30, s29, s30
    v_lshrrev_b32 v17, 3, v1
    v_add_u32 v18, s30, v17
    v_mul_u32_u24 v18, 1280, v18
    v_and_b32 v19, 7, v1
    v_xor_b32 v19, v19, v17
    v_lshl_add_u32 v15, v19, 4, v18
    s_mul_i32 s58, s45, 37
    s_lshr_b32 s58, s58, 8
    s_mul_i32 s59, s58, 7
    s_sub_u32 s59, s45, s59
    s_mul_i32 s59, s59, 3
    s_mul_i32 s58, s58, 5
    s_lshr_b32 s58, s58, 1
    s_add_u32 s56, s58, s59
    s_add_u32 s56, s56, s44
    s_mul_i32 s57, s56, 6554
    s_lshr_b32 s57, s57, 16
    s_mul_i32 s57, s57, 10
    s_sub_u32 s56, s56, s57
    s_lshl_b32 s31, s46, 8
    v_lshlrev_b32 v16, 2, v1
    s_mov_b32 s4, s66
    s_and_b32 s5, s67, 0xffff
    s_mov_b32 s6, 163840
    s_mov_b32 s7, 0x00020000
    buffer_load_dword v10, v16, s[4:7], s31 offen
    s_mov_b32 s4, s68
    s_and_b32 s5, s69, 0xffff
    s_mov_b32 s6, 163840
    s_mov_b32 s7, 0x00020000
    buffer_load_dword v11, v16, s[4:7], s31 offen
    s_mov_b32 s4, s70
    s_and_b32 s5, s71, 0xffff
    s_mov_b32 s6, 163840
    s_mov_b32 s7, 0x00020000
    buffer_load_dword v12, v16, s[4:7], s31 offen
    s_mov_b32 s4, s72
    s_and_b32 s5, s73, 0xffff
    s_mov_b32 s6, 163840
    s_mov_b32 s7, 0x00020000
    buffer_load_dword v13, v16, s[4:7], s31 offen
    s_mov_b32 s4, s90
    s_and_b32 s5, s91, 0xffff
    s_mov_b32 s6, 256
    s_mov_b32 s7, 0x00020000
    v_mov_b32 v141, 0
    buffer_load_dword v140, v141, s[4:7], 0 offen sc1
    v_mov_b32 v20, 163792
    v_mov_b32 v22, 0
    v_mov_b32 v23, 0
    ds_write_b64 v20, v[22:23]
    ds_write_b64 v20, v[22:23] offset:8
    s_cmp_lg_u32 s28, 7
    s_cbranch_scc1 ld_pro_other
    v_lshrrev_b32 v20, 4, v1
    v_lshlrev_b32 v21, 1, v20
    v_and_b32 v22, 15, v1
    v_xor_b32 v21, v21, v22
    v_lshlrev_b32 v17, 4, v21
    v_xor_b32 v18, 128, v17
    v_mul_u32_u24 v20, 3456, v20
    s_lshl_b32 s30, s41, 8
    v_add3_u32 v17, v17, v20, s30
    v_add3_u32 v18, v18, v20, s30
    v_lshrrev_b32 v20, 3, v1
    v_add_u32 v21, s29, v20
    v_mul_u32_u24 v21, 1280, v21
    v_and_b32 v22, 7, v1
    v_xor_b32 v22, v22, v20
    v_lshl_add_u32 v19, v22, 4, v21
    s_add_u32 s58, s56, 0
    s_cmp_ge_u32 s58, 10
    s_cselect_b32 s59, 10, 0
    s_sub_u32 s58, s58, s59
    s_lshl_b32 s33, s58, 7
    s_mul_i32 s34, s58, 221184
    s_mov_b32 m0, 16384
    s_add_u32 s31, s33, 0
    buffer_load_dwordx4 v19, s[8:11], s31 offen lds
    s_mov_b32 m0, 0
    s_add_u32 s31, s34, 0
    buffer_load_dwordx4 v17, s[12:15], s31 offen lds
    s_mov_b32 m0, 17408
    s_add_u32 s31, s33, 10240
    buffer_load_dwordx4 v19, s[8:11], s31 offen lds
    s_mov_b32 m0, 1024
    s_add_u32 s31, s34, 13824
    buffer_load_dwordx4 v17, s[12:15], s31 offen lds
    s_mov_b32 m0, 18432
    s_add_u32 s31, s33, 20480
    buffer_load_dwordx4 v19, s[8:11], s31 offen lds
    s_mov_b32 m0, 2048
    s_add_u32 s31, s34, 27648
    buffer_load_dwordx4 v18, s[12:15], s31 offen lds
    s_mov_b32 m0, 19456
    s_add_u32 s31, s33, 30720
    buffer_load_dwordx4 v19, s[8:11], s31 offen lds
    s_mov_b32 m0, 3072
    s_add_u32 s31, s34, 41472
    buffer_load_dwordx4 v18, s[12:15], s31 offen lds
    s_mov_b32 m0, 20480
    s_add_u32 s31, s33, 40960
    buffer_load_dwordx4 v19, s[8:11], s31 offen lds
    s_mov_b32 m0, 4096
    s_add_u32 s31, s34, 55296
    buffer_load_dwordx4 v17, s[12:15], s31 offen lds
    s_mov_b32 m0, 21504
    s_add_u32 s31, s33, 51200
    buffer_load_dwordx4 v19, s[8:11], s31 offen lds
    s_mov_b32 m0, 5120
    s_add_u32 s31, s34, 69120
    buffer_load_dwordx4 v17, s[12:15], s31 offen lds
    s_mov_b32 m0, 22528
    s_add_u32 s31, s33, 61440
    buffer_load_dwordx4 v19, s[8:11], s31 offen lds
    s_mov_b32 m0, 6144
    s_add_u32 s31, s34, 82944
    buffer_load_dwordx4 v18, s[12:15], s31 offen lds
    s_mov_b32 m0, 23552
    s_add_u32 s31, s33, 71680
    buffer_load_dwordx4 v19, s[8:11], s31 offen lds
    s_mov_b32 m0, 7168
    s_add_u32 s31, s34, 96768
    buffer_load_dwordx4 v18, s[12:15], s31 offen lds
    s_mov_b32 m0, 24576
    s_add_u32 s31, s33, 81920
    buffer_load_dwordx4 v19, s[8:11], s31 offen lds
    s_mov_b32 m0, 8192
    s_add_u32 s31, s34, 110592
    buffer_load_dwordx4 v17, s[12:15], s31 offen lds
    s_mov_b32 m0, 25600
    s_add_u32 s31, s33, 92160
    buffer_load_dwordx4 v19, s[8:11], s31 offen lds
    s_mov_b32 m0, 9216
    s_add_u32 s31, s34, 124416
    buffer_load_dwordx4 v17, s[12:15], s31 offen lds
    s_mov_b32 m0, 26624
    s_add_u32 s31, s33, 102400
    buffer_load_dwordx4 v19, s[8:11], s31 offen lds
    s_mov_b32 m0, 10240
    s_add_u32 s31, s34, 138240
    buffer_load_dwordx4 v18, s[12:15], s31 offen lds
    s_mov_b32 m0, 27648
    s_add_u32 s31, s33, 112640
    buffer_load_dwordx4 v19, s[8:11], s31 offen lds
    s_mov_b32 m0, 11264
    s_add_u32 s31, s34, 152064
    buffer_load_dwordx4 v18, s[12:15], s31 offen lds
    s_mov_b32 m0, 28672
    s_add_u32 s31, s33, 122880
    buffer_load_dwordx4 v19, s[8:11], s31 offen lds
    s_mov_b32 m0, 12288
    s_add_u32 s31, s34, 165888
    buffer_load_dwordx4 v17, s[12:15], s31 offen lds
    s_mov_b32 m0, 29696
    s_add_u32 s31, s33, 133120
    buffer_load_dwordx4 v19, s[8:11], s31 offen lds
    s_mov_b32 m0, 13312
    s_add_u32 s31, s34, 179712
    buffer_load_dwordx4 v17, s[12:15], s31 offen lds
    s_mov_b32 m0, 30720
    s_add_u32 s31, s33, 143360
    buffer_load_dwordx4 v19, s[8:11], s31 offen lds
    s_mov_b32 m0, 14336
    s_add_u32 s31, s34, 193536
    buffer_load_dwordx4 v18, s[12:15], s31 offen lds
    s_mov_b32 m0, 31744
    s_add_u32 s31, s33, 153600
    buffer_load_dwordx4 v19, s[8:11], s31 offen lds
    s_mov_b32 m0, 15360
    s_add_u32 s31, s34, 207360
    buffer_load_dwordx4 v18, s[12:15], s31 offen lds
    s_add_u32 s58, s56, 1
    s_cmp_ge_u32 s58, 10
    s_cselect_b32 s59, 10, 0
    s_sub_u32 s58, s58, s59
    s_lshl_b32 s33, s58, 7
    s_mul_i32 s34, s58, 221184
    s_mov_b32 m0, 49152
    s_add_u32 s31, s33, 0
    buffer_load_dwordx4 v19, s[8:11], s31 offen lds
    s_mov_b32 m0, 32768
    s_add_u32 s31, s34, 0
    buffer_load_dwordx4 v17, s[12:15], s31 offen lds
    s_mov_b32 m0, 50176
    s_add_u32 s31, s33, 10240
    buffer_load_dwordx4 v19, s[8:11], s31 offen lds
    s_mov_b32 m0, 33792
    s_add_u32 s31, s34, 13824
    buffer_load_dwordx4 v17, s[12:15], s31 offen lds
    s_mov_b32 m0, 51200
    s_add_u32 s31, s33, 20480
    buffer_load_dwordx4 v19, s[8:11], s31 offen lds
    s_mov_b32 m0, 34816
    s_add_u32 s31, s34, 27648
    buffer_load_dwordx4 v18, s[12:15], s31 offen lds
    s_mov_b32 m0, 52224
    s_add_u32 s31, s33, 30720
    buffer_load_dwordx4 v19, s[8:11], s31 offen lds
    s_mov_b32 m0, 35840
    s_add_u32 s31, s34, 41472
    buffer_load_dwordx4 v18, s[12:15], s31 offen lds
    s_mov_b32 m0, 53248
    s_add_u32 s31, s33, 40960
    buffer_load_dwordx4 v19, s[8:11], s31 offen lds
    s_mov_b32 m0, 36864
    s_add_u32 s31, s34, 55296
    buffer_load_dwordx4 v17, s[12:15], s31 offen lds
    s_mov_b32 m0, 54272
    s_add_u32 s31, s33, 51200
    buffer_load_dwordx4 v19, s[8:11], s31 offen lds
    s_mov_b32 m0, 37888
    s_add_u32 s31, s34, 69120
    buffer_load_dwordx4 v17, s[12:15], s31 offen lds
    s_mov_b32 m0, 55296
    s_add_u32 s31, s33, 61440
    buffer_load_dwordx4 v19, s[8:11], s31 offen lds
    s_mov_b32 m0, 38912
    s_add_u32 s31, s34, 82944
    buffer_load_dwordx4 v18, s[12:15], s31 offen lds
    s_mov_b32 m0, 56320
    s_add_u32 s31, s33, 71680
    buffer_load_dwordx4 v19, s[8:11], s31 offen lds
    s_mov_b32 m0, 39936
    s_add_u32 s31, s34, 96768
    buffer_load_dwordx4 v18, s[12:15], s31 offen lds
    s_mov_b32 m0, 57344
    s_add_u32 s31, s33, 81920
    buffer_load_dwordx4 v19, s[8:11], s31 offen lds
    s_mov_b32 m0, 40960
    s_add_u32 s31, s34, 110592
    buffer_load_dwordx4 v17, s[12:15], s31 offen lds
    s_mov_b32 m0, 58368
    s_add_u32 s31, s33, 92160
    buffer_load_dwordx4 v19, s[8:11], s31 offen lds
    s_mov_b32 m0, 41984
    s_add_u32 s31, s34, 124416
    buffer_load_dwordx4 v17, s[12:15], s31 offen lds
    s_mov_b32 m0, 59392
    s_add_u32 s31, s33, 102400
    buffer_load_dwordx4 v19, s[8:11], s31 offen lds
    s_mov_b32 m0, 43008
    s_add_u32 s31, s34, 138240
    buffer_load_dwordx4 v18, s[12:15], s31 offen lds
    s_mov_b32 m0, 60416
    s_add_u32 s31, s33, 112640
    buffer_load_dwordx4 v19, s[8:11], s31 offen lds
    s_mov_b32 m0, 44032
    s_add_u32 s31, s34, 152064
    buffer_load_dwordx4 v18, s[12:15], s31 offen lds
    s_mov_b32 m0, 61440
    s_add_u32 s31, s33, 122880
    buffer_load_dwordx4 v19, s[8:11], s31 offen lds
    s_mov_b32 m0, 45056
    s_add_u32 s31, s34, 165888
    buffer_load_dwordx4 v17, s[12:15], s31 offen lds
    s_mov_b32 m0, 62464
    s_add_u32 s31, s33, 133120
    buffer_load_dwordx4 v19, s[8:11], s31 offen lds
    s_mov_b32 m0, 46080
    s_add_u32 s31, s34, 179712
    buffer_load_dwordx4 v17, s[12:15], s31 offen lds
    s_mov_b32 m0, 63488
    s_add_u32 s31, s33, 143360
    buffer_load_dwordx4 v19, s[8:11], s31 offen lds
    s_mov_b32 m0, 47104
    s_add_u32 s31, s34, 193536
    buffer_load_dwordx4 v18, s[12:15], s31 offen lds
    s_mov_b32 m0, 64512
    s_add_u32 s31, s33, 153600
    buffer_load_dwordx4 v19, s[8:11], s31 offen lds
    s_mov_b32 m0, 48128
    s_add_u32 s31, s34, 207360
    buffer_load_dwordx4 v18, s[12:15], s31 offen lds
    s_branch ld_pro_done
ld_pro_other:
    s_waitcnt lgkmcnt(0)
    s_bitcmp1_b32 s46, 0
    s_cbranch_scc1 ch_odd3
    s_lshl_b32 s48, s48, 16
    s_lshl_b32 s49, s49, 16
ch_odd3:
    s_and_b32 s48, s48, 0xffff0000
    s_and_b32 s49, s49, 0xffff0000
    s_cmp_eq_u32 s47, 0
    s_cbranch_scc1 kgen1_skip
    v_mov_b32 v3, s48
    v_mul_f32 v3, 0x3fb8aa3b, v3
    v_exp_f32 v3, v3
    s_nop 0
    v_cvt_pk_bf16_f32 v3, v3, v3
    v_lshlrev_b32 v3, 16, v3
    v_add_f32 v4, v3, v3
    v_readfirstlane_b32 s24, v3
    v_readfirstlane_b32 s25, v4
    s_and_b32 s30, s28, 3
    s_mul_i32 s31, s30, 15616
    s_add_u32 s31, s31, 65536
    s_cmp_eq_u32 s30, 2
    s_cselect_b32 s31, 146688, s31
    v_mov_b32 v2, s31
    s_waitcnt vmcnt(1)
    v_lshl_add_u32 v4, v1, 2, v2
    v_and_b32 v5, 15, v1
    v_mul_u32_u24 v5, 272, v5
    v_lshrrev_b32 v6, 4, v1
    v_lshl_add_u32 v5, v6, 4, v5
    v_add_u32 v5, v5, v2
    v_and_b32 v50, 0xffff0000, v10
    v_and_b32 v51, 0xffff0000, v11
    v_and_b32 v32, 0xffff0000, v12
    v_and_b32 v33, 0xffff0000, v13
    v_mul_f32 v50, 0x3fb8aa3b, v50
    v_exp_f32 v50, v50
    v_mul_f32 v51, s24, v51
    v_cvt_pk_bf16_f32 v50, v50, v50
    v_mul_f32 v51, 0x3e22f983, v51
    v_lshlrev_b32 v50, 16, v50
    v_mul_f32 v50, s24, v50
    v_mul_f32 v32, s25, v32
    v_mul_f32 v50, 0xbfb8aa3b, v50
    v_mul_f32_e64 v33, -v33, s25
    v_mul_f32 v52, 0x3f800000, v50
    v_mul_f32 v53, 0x3f800000, v51
    v_exp_f32 v52, v52
    v_fract_f32 v53, v53
    v_cos_f32 v54, v53
    v_sin_f32 v55, v53
    v_mul_f32 v20, v52, v54
    v_mul_f32_e64 v21, -v52, v55
    v_mul_f32 v52, 0x41000000, v50
    v_mul_f32 v53, 0x41000000, v51
    v_exp_f32 v52, v52
    v_fract_f32 v53, v53
    v_cos_f32 v54, v53
    v_sin_f32 v55, v53
    v_mul_f32 v28, v52, v54
    v_mul_f32 v29, v52, v55
    v_mul_f32 v52, 0x43000000, v50
    v_mul_f32 v53, 0x43000000, v51
    v_exp_f32 v52, v52
    v_fract_f32 v53, v53
    v_cos_f32 v54, v53
    v_sin_f32 v55, v53
    v_mul_f32 v26, v52, v54
    v_mul_f32_e64 v27, -v52, v55
    v_pk_mul_f32 v[30:31], v[20:21], v[20:21] op_sel:[1,1] op_sel_hi:[1,0] neg_lo:[1,0]
    v_pk_fma_f32 v[22:23], v[20:21], v[20:21], v[30:31] op_sel:[0,0,0] op_sel_hi:[0,1,1]
    v_pk_mul_f32 v[30:31], v[22:23], v[22:23] op_sel:[1,1] op_sel_hi:[1,0] neg_lo:[1,0]
    v_pk_fma_f32 v[24:25], v[22:23], v[22:23], v[30:31] op_sel:[0,0,0] op_sel_hi:[0,1,1]
    v_mov_b32 v48, 1.0
    v_mov_b32 v49, 0
    v_cvt_pk_bf16_f32 v56, v32, v33
    ds_write_b32 v4, v56 offset:0
    v_pk_mul_f32 v[30:31], v[32:33], v[20:21] op_sel:[1,1] op_sel_hi:[1,0] neg_lo:[1,0]
    v_pk_fma_f32 v[34:35], v[32:33], v[20:21], v[30:31] op_sel:[0,0,0] op_sel_hi:[0,1,1]
    v_cvt_pk_bf16_f32 v57, v34, v35
    ds_write_b32 v4, v57 offset:272
    v_pk_mul_f32 v[30:31], v[34:35], v[20:21] op_sel:[1,1] op_sel_hi:[1,0] neg_lo:[1,0]
    v_pk_fma_f32 v[36:37], v[34:35], v[20:21], v[30:31] op_sel:[0,0,0] op_sel_hi:[0,1,1]
    v_cvt_pk_bf16_f32 v58, v36, v37
    ds_write_b32 v4, v58 offset:544
    v_cvt_pk_bf16_f32 v59, v48, v49
    ds_write_b32 v4, v59 offset:11152
    v_cvt_pk_bf16_f32 v56, v28, v29
    ds_write_b32 v4, v56 offset:11424
    v_pk_mul_f32 v[30:31], v[36:37], v[20:21] op_sel:[1,1] op_sel_hi:[1,0] neg_lo:[1,0]
    v_pk_fma_f32 v[38:39], v[36:37], v[20:21], v[30:31] op_sel:[0,0,0] op_sel_hi:[0,1,1]
    v_cvt_pk_bf16_f32 v57, v38, v39
    ds_write_b32 v4, v57 offset:816
    v_pk_mul_f32 v[30:31], v[38:39], v[20:21] op_sel:[1,1] op_sel_hi:[1,0] neg_lo:[1,0]
    v_pk_fma_f32 v[40:41], v[38:39], v[20:21], v[30:31] op_sel:[0,0,0] op_sel_hi:[0,1,1]
    v_cvt_pk_bf16_f32 v58, v40, v41
    ds_write_b32 v4, v58 offset:1088
    v_pk_mul_f32 v[30:31], v[40:41], v[20:21] op_sel:[1,1] op_sel_hi:[1,0] neg_lo:[1,0]
    v_pk_fma_f32 v[42:43], v[40:41], v[20:21], v[30:31] op_sel:[0,0,0] op_sel_hi:[0,1,1]
    v_pk_mul_f32 v[52:53], v[28:29], v[28:29] op_sel:[1,1] op_sel_hi:[1,0] neg_lo:[1,0]
    v_pk_fma_f32 v[48:49], v[28:29], v[28:29], v[52:53] op_sel:[0,0,0] op_sel_hi:[0,1,1]
    v_cvt_pk_bf16_f32 v59, v48, v49
    ds_write_b32 v4, v59 offset:11696
    v_cvt_pk_bf16_f32 v56, v42, v43
    ds_write_b32 v4, v56 offset:1360
    v_pk_mul_f32 v[30:31], v[42:43], v[20:21] op_sel:[1,1] op_sel_hi:[1,0] neg_lo:[1,0]
    v_pk_fma_f32 v[44:45], v[42:43], v[20:21], v[30:31] op_sel:[0,0,0] op_sel_hi:[0,1,1]
    v_cvt_pk_bf16_f32 v57, v44, v45
    ds_write_b32 v4, v57 offset:1632
    v_pk_mul_f32 v[30:31], v[44:45], v[20:21] op_sel:[1,1] op_sel_hi:[1,0] neg_lo:[1,0]
    v_pk_fma_f32 v[46:47], v[44:45], v[20:21], v[30:31] op_sel:[0,0,0] op_sel_hi:[0,1,1]
    v_cvt_pk_bf16_f32 v58, v46, v47
    ds_write_b32 v4, v58 offset:1904
    v_pk_mul_f32 v[52:53], v[48:49], v[28:29] op_sel:[1,1] op_sel_hi:[1,0] neg_lo:[1,0]
    v_pk_fma_f32 v[48:49], v[48:49], v[28:29], v[52:53] op_sel:[0,0,0] op_sel_hi:[0,1,1]
    v_cvt_pk_bf16_f32 v59, v48, v49
    ds_write_b32 v4, v59 offset:11968
    v_pk_mul_f32 v[30:31], v[32:33], v[26:27] op_sel:[1,1] op_sel_hi:[1,0] neg_lo:[1,0]
    v_pk_fma_f32 v[32:33], v[32:33], v[26:27], v[30:31] op_sel:[0,0,0] op_sel_hi:[0,1,1]
    v_cvt_pk_bf16_f32 v56, v32, v33
    ds_write_b32 v4, v56 offset:2176
    v_pk_mul_f32 v[30:31], v[34:35], v[26:27] op_sel:[1,1] op_sel_hi:[1,0] neg_lo:[1,0]
    v_pk_fma_f32 v[34:35], v[34:35], v[26:27], v[30:31] op_sel:[0,0,0] op_sel_hi:[0,1,1]
    v_cvt_pk_bf16_f32 v57, v34, v35
    ds_write_b32 v4, v57 offset:2448
    v_pk_mul_f32 v[30:31], v[36:37], v[26:27] op_sel:[1,1] op_sel_hi:[1,0] neg_lo:[1,0]
    v_pk_fma_f32 v[36:37], v[36:37], v[26:27], v[30:31] op_sel:[0,0,0] op_sel_hi:[0,1,1]
    v_pk_mul_f32 v[52:53], v[48:49], v[28:29] op_sel:[1,1] op_sel_hi:[1,0] neg_lo:[1,0]
    v_pk_fma_f32 v[48:49], v[48:49], v[28:29], v[52:53] op_sel:[0,0,0] op_sel_hi:[0,1,1]
    v_cvt_pk_bf16_f32 v58, v48, v49
    ds_write_b32 v4, v58 offset:12240
    v_cvt_pk_bf16_f32 v59, v36, v37
    ds_write_b32 v4, v59 offset:2720
    v_pk_mul_f32 v[30:31], v[38:39], v[26:27] op_sel:[1,1] op_sel_hi:[1,0] neg_lo:[1,0]
    v_pk_fma_f32 v[38:39], v[38:39], v[26:27], v[30:31] op_sel:[0,0,0] op_sel_hi:[0,1,1]
    v_cvt_pk_bf16_f32 v56, v38, v39
    ds_write_b32 v4, v56 offset:2992
    v_pk_mul_f32 v[30:31], v[40:41], v[26:27] op_sel:[1,1] op_sel_hi:[1,0] neg_lo:[1,0]
    v_pk_fma_f32 v[40:41], v[40:41], v[26:27], v[30:31] op_sel:[0,0,0] op_sel_hi:[0,1,1]
    v_cvt_pk_bf16_f32 v57, v40, v41
    ds_write_b32 v4, v57 offset:3264
    v_pk_mul_f32 v[52:53], v[48:49], v[28:29] op_sel:[1,1] op_sel_hi:[1,0] neg_lo:[1,0]
    v_pk_fma_f32 v[48:49], v[48:49], v[28:29], v[52:53] op_sel:[0,0,0] op_sel_hi:[0,1,1]
    v_cvt_pk_bf16_f32 v58, v48, v49
    ds_write_b32 v4, v58 offset:12512
    v_pk_mul_f32 v[30:31], v[42:43], v[26:27] op_sel:[1,1] op_sel_hi:[1,0] neg_lo:[1,0]
    v_pk_fma_f32 v[42:43], v[42:43], v[26:27], v[30:31] op_sel:[0,0,0] op_sel_hi:[0,1,1]
    v_cvt_pk_bf16_f32 v59, v42, v43
    ds_write_b32 v4, v59 offset:3536
    v_pk_mul_f32 v[30:31], v[44:45], v[26:27] op_sel:[1,1] op_sel_hi:[1,0] neg_lo:[1,0]
    v_pk_fma_f32 v[44:45], v[44:45], v[26:27], v[30:31] op_sel:[0,0,0] op_sel_hi:[0,1,1]
    v_cvt_pk_bf16_f32 v56, v44, v45
    ds_write_b32 v4, v56 offset:3808
    v_pk_mul_f32 v[30:31], v[46:47], v[26:27] op_sel:[1,1] op_sel_hi:[1,0] neg_lo:[1,0]
    v_pk_fma_f32 v[46:47], v[46:47], v[26:27], v[30:31] op_sel:[0,0,0] op_sel_hi:[0,1,1]
    v_pk_mul_f32 v[52:53], v[48:49], v[28:29] op_sel:[1,1] op_sel_hi:[1,0] neg_lo:[1,0]
    v_pk_fma_f32 v[48:49], v[48:49], v[28:29], v[52:53] op_sel:[0,0,0] op_sel_hi:[0,1,1]
    v_cvt_pk_bf16_f32 v57, v48, v49
    ds_write_b32 v4, v57 offset:12784
    v_cvt_pk_bf16_f32 v58, v46, v47
    ds_write_b32 v4, v58 offset:4080
    v_pk_mul_f32 v[30:31], v[32:33], v[26:27] op_sel:[1,1] op_sel_hi:[1,0] neg_lo:[1,0]
    v_pk_fma_f32 v[32:33], v[32:33], v[26:27], v[30:31] op_sel:[0,0,0] op_sel_hi:[0,1,1]
    v_cvt_pk_bf16_f32 v59, v32, v33
    ds_write_b32 v4, v59 offset:4352
    v_pk_mul_f32 v[30:31], v[32:33], v[22:23] op_sel:[1,1] op_sel_hi:[1,0] neg_lo:[1,0]
    v_pk_fma_f32 v[34:35], v[32:33], v[22:23], v[30:31] op_sel:[0,0,0] op_sel_hi:[0,1,1]
    v_cvt_pk_bf16_f32 v56, v34, v35
    ds_write_b32 v4, v56 offset:4624
    v_pk_mul_f32 v[52:53], v[48:49], v[28:29] op_sel:[1,1] op_sel_hi:[1,0] neg_lo:[1,0]
    v_pk_fma_f32 v[48:49], v[48:49], v[28:29], v[52:53] op_sel:[0,0,0] op_sel_hi:[0,1,1]
    v_cvt_pk_bf16_f32 v57, v48, v49
    ds_write_b32 v4, v57 offset:13056
    v_pk_mul_f32 v[30:31], v[34:35], v[22:23] op_sel:[1,1] op_sel_hi:[1,0] neg_lo:[1,0]
    v_pk_fma_f32 v[36:37], v[34:35], v[22:23], v[30:31] op_sel:[0,0,0] op_sel_hi:[0,1,1]
    v_cvt_pk_bf16_f32 v58, v36, v37
    ds_write_b32 v4, v58 offset:4896
    v_pk_mul_f32 v[30:31], v[36:37], v[22:23] op_sel:[1,1] op_sel_hi:[1,0] neg_lo:[1,0]
    v_pk_fma_f32 v[38:39], v[36:37], v[22:23], v[30:31] op_sel:[0,0,0] op_sel_hi:[0,1,1]
    v_cvt_pk_bf16_f32 v59, v38, v39
    ds_write_b32 v4, v59 offset:5168
    v_pk_mul_f32 v[30:31], v[32:33], v[26:27] op_sel:[1,1] op_sel_hi:[1,0] neg_lo:[1,0]
    v_pk_fma_f32 v[32:33], v[32:33], v[26:27], v[30:31] op_sel:[0,0,0] op_sel_hi:[0,1,1]
    v_pk_mul_f32 v[52:53], v[48:49], v[28:29] op_sel:[1,1] op_sel_hi:[1,0] neg_lo:[1,0]
    v_pk_fma_f32 v[48:49], v[48:49], v[28:29], v[52:53] op_sel:[0,0,0] op_sel_hi:[0,1,1]
    v_cvt_pk_bf16_f32 v56, v48, v49
    ds_write_b32 v4, v56 offset:13328
    v_cvt_pk_bf16_f32 v57, v32, v33
    ds_write_b32 v4, v57 offset:5440
    v_pk_mul_f32 v[30:31], v[34:35], v[26:27] op_sel:[1,1] op_sel_hi:[1,0] neg_lo:[1,0]
    v_pk_fma_f32 v[34:35], v[34:35], v[26:27], v[30:31] op_sel:[0,0,0] op_sel_hi:[0,1,1]
    v_cvt_pk_bf16_f32 v58, v34, v35
    ds_write_b32 v4, v58 offset:5712
    v_pk_mul_f32 v[30:31], v[36:37], v[26:27] op_sel:[1,1] op_sel_hi:[1,0] neg_lo:[1,0]
    v_pk_fma_f32 v[36:37], v[36:37], v[26:27], v[30:31] op_sel:[0,0,0] op_sel_hi:[0,1,1]
    v_cvt_pk_bf16_f32 v59, v36, v37
    ds_write_b32 v4, v59 offset:5984
    v_pk_mul_f32 v[52:53], v[48:49], v[28:29] op_sel:[1,1] op_sel_hi:[1,0] neg_lo:[1,0]
    v_pk_fma_f32 v[48:49], v[48:49], v[28:29], v[52:53] op_sel:[0,0,0] op_sel_hi:[0,1,1]
    v_cvt_pk_bf16_f32 v56, v48, v49
    ds_write_b32 v4, v56 offset:13600
    v_pk_mul_f32 v[30:31], v[38:39], v[26:27] op_sel:[1,1] op_sel_hi:[1,0] neg_lo:[1,0]
    v_pk_fma_f32 v[38:39], v[38:39], v[26:27], v[30:31] op_sel:[0,0,0] op_sel_hi:[0,1,1]
    v_cvt_pk_bf16_f32 v57, v38, v39
    ds_write_b32 v4, v57 offset:6256
    v_pk_mul_f32 v[30:31], v[32:33], v[26:27] op_sel:[1,1] op_sel_hi:[1,0] neg_lo:[1,0]
    v_pk_fma_f32 v[32:33], v[32:33], v[26:27], v[30:31] op_sel:[0,0,0] op_sel_hi:[0,1,1]
    v_cvt_pk_bf16_f32 v58, v32, v33
    ds_write_b32 v4, v58 offset:6528
    v_pk_mul_f32 v[30:31], v[32:33], v[24:25] op_sel:[1,1] op_sel_hi:[1,0] neg_lo:[1,0]
    v_pk_fma_f32 v[34:35], v[32:33], v[24:25], v[30:31] op_sel:[0,0,0] op_sel_hi:[0,1,1]
    v_pk_mul_f32 v[52:53], v[48:49], v[28:29] op_sel:[1,1] op_sel_hi:[1,0] neg_lo:[1,0]
    v_pk_fma_f32 v[48:49], v[48:49], v[28:29], v[52:53] op_sel:[0,0,0] op_sel_hi:[0,1,1]
    v_cvt_pk_bf16_f32 v59, v48, v49
    ds_write_b32 v4, v59 offset:13872
    v_cvt_pk_bf16_f32 v56, v34, v35
    ds_write_b32 v4, v56 offset:6800
    v_pk_mul_f32 v[30:31], v[32:33], v[26:27] op_sel:[1,1] op_sel_hi:[1,0] neg_lo:[1,0]
    v_pk_fma_f32 v[32:33], v[32:33], v[26:27], v[30:31] op_sel:[0,0,0] op_sel_hi:[0,1,1]
    v_cvt_pk_bf16_f32 v57, v32, v33
    ds_write_b32 v4, v57 offset:7072
    v_pk_mul_f32 v[30:31], v[34:35], v[26:27] op_sel:[1,1] op_sel_hi:[1,0] neg_lo:[1,0]
    v_pk_fma_f32 v[34:35], v[34:35], v[26:27], v[30:31] op_sel:[0,0,0] op_sel_hi:[0,1,1]
    v_cvt_pk_bf16_f32 v58, v34, v35
    ds_write_b32 v4, v58 offset:7344
    v_pk_mul_f32 v[52:53], v[48:49], v[28:29] op_sel:[1,1] op_sel_hi:[1,0] neg_lo:[1,0]
    v_pk_fma_f32 v[48:49], v[48:49], v[28:29], v[52:53] op_sel:[0,0,0] op_sel_hi:[0,1,1]
    v_cvt_pk_bf16_f32 v59, v48, v49
    ds_write_b32 v4, v59 offset:14144
    v_pk_mul_f32 v[30:31], v[32:33], v[26:27] op_sel:[1,1] op_sel_hi:[1,0] neg_lo:[1,0]
    v_pk_fma_f32 v[32:33], v[32:33], v[26:27], v[30:31] op_sel:[0,0,0] op_sel_hi:[0,1,1]
    v_cvt_pk_bf16_f32 v56, v32, v33
    ds_write_b32 v4, v56 offset:7616
    v_pk_mul_f32 v[30:31], v[34:35], v[26:27] op_sel:[1,1] op_sel_hi:[1,0] neg_lo:[1,0]
    v_pk_fma_f32 v[34:35], v[34:35], v[26:27], v[30:31] op_sel:[0,0,0] op_sel_hi:[0,1,1]
    v_cvt_pk_bf16_f32 v57, v34, v35
    ds_write_b32 v4, v57 offset:7888
    v_pk_mul_f32 v[30:31], v[32:33], v[26:27] op_sel:[1,1] op_sel_hi:[1,0] neg_lo:[1,0]
    v_pk_fma_f32 v[32:33], v[32:33], v[26:27], v[30:31] op_sel:[0,0,0] op_sel_hi:[0,1,1]
    v_pk_mul_f32 v[52:53], v[48:49], v[28:29] op_sel:[1,1] op_sel_hi:[1,0] neg_lo:[1,0]
    v_pk_fma_f32 v[48:49], v[48:49], v[28:29], v[52:53] op_sel:[0,0,0] op_sel_hi:[0,1,1]
    v_cvt_pk_bf16_f32 v58, v48, v49
    ds_write_b32 v4, v58 offset:14416
    v_cvt_pk_bf16_f32 v59, v32, v33
    ds_write_b32 v4, v59 offset:8160
    v_pk_mul_f32 v[30:31], v[34:35], v[26:27] op_sel:[1,1] op_sel_hi:[1,0] neg_lo:[1,0]
    v_pk_fma_f32 v[34:35], v[34:35], v[26:27], v[30:31] op_sel:[0,0,0] op_sel_hi:[0,1,1]
    v_cvt_pk_bf16_f32 v56, v34, v35
    ds_write_b32 v4, v56 offset:8432
    v_pk_mul_f32 v[30:31], v[32:33], v[26:27] op_sel:[1,1] op_sel_hi:[1,0] neg_lo:[1,0]
    v_pk_fma_f32 v[32:33], v[32:33], v[26:27], v[30:31] op_sel:[0,0,0] op_sel_hi:[0,1,1]
    v_cvt_pk_bf16_f32 v57, v32, v33
    ds_write_b32 v4, v57 offset:8704
    v_pk_mul_f32 v[52:53], v[48:49], v[28:29] op_sel:[1,1] op_sel_hi:[1,0] neg_lo:[1,0]
    v_pk_fma_f32 v[48:49], v[48:49], v[28:29], v[52:53] op_sel:[0,0,0] op_sel_hi:[0,1,1]
    v_cvt_pk_bf16_f32 v58, v48, v49
    ds_write_b32 v4, v58 offset:14688
    v_pk_mul_f32 v[30:31], v[32:33], v[26:27] op_sel:[1,1] op_sel_hi:[1,0] neg_lo:[1,0]
    v_pk_fma_f32 v[32:33], v[32:33], v[26:27], v[30:31] op_sel:[0,0,0] op_sel_hi:[0,1,1]
    v_cvt_pk_bf16_f32 v59, v32, v33
    ds_write_b32 v4, v59 offset:8976
    v_pk_mul_f32 v[30:31], v[32:33], v[26:27] op_sel:[1,1] op_sel_hi:[1,0] neg_lo:[1,0]
    v_pk_fma_f32 v[32:33], v[32:33], v[26:27], v[30:31] op_sel:[0,0,0] op_sel_hi:[0,1,1]
    v_cvt_pk_bf16_f32 v56, v32, v33
    ds_write_b32 v4, v56 offset:9248
    v_pk_mul_f32 v[30:31], v[32:33], v[26:27] op_sel:[1,1] op_sel_hi:[1,0] neg_lo:[1,0]
    v_pk_fma_f32 v[32:33], v[32:33], v[26:27], v[30:31] op_sel:[0,0,0] op_sel_hi:[0,1,1]
    v_pk_mul_f32 v[52:53], v[48:49], v[28:29] op_sel:[1,1] op_sel_hi:[1,0] neg_lo:[1,0]
    v_pk_fma_f32 v[48:49], v[48:49], v[28:29], v[52:53] op_sel:[0,0,0] op_sel_hi:[0,1,1]
    v_cvt_pk_bf16_f32 v57, v48, v49
    ds_write_b32 v4, v57 offset:14960
    v_cvt_pk_bf16_f32 v58, v32, v33
    ds_write_b32 v4, v58 offset:9520
    v_pk_mul_f32 v[30:31], v[32:33], v[26:27] op_sel:[1,1] op_sel_hi:[1,0] neg_lo:[1,0]
    v_pk_fma_f32 v[32:33], v[32:33], v[26:27], v[30:31] op_sel:[0,0,0] op_sel_hi:[0,1,1]
    v_cvt_pk_bf16_f32 v59, v32, v33
    ds_write_b32 v4, v59 offset:9792
    v_pk_mul_f32 v[30:31], v[32:33], v[26:27] op_sel:[1,1] op_sel_hi:[1,0] neg_lo:[1,0]
    v_pk_fma_f32 v[32:33], v[32:33], v[26:27], v[30:31] op_sel:[0,0,0] op_sel_hi:[0,1,1]
    v_cvt_pk_bf16_f32 v56, v32, v33
    ds_write_b32 v4, v56 offset:10064
    v_pk_mul_f32 v[52:53], v[48:49], v[28:29] op_sel:[1,1] op_sel_hi:[1,0] neg_lo:[1,0]
    v_pk_fma_f32 v[48:49], v[48:49], v[28:29], v[52:53] op_sel:[0,0,0] op_sel_hi:[0,1,1]
    v_cvt_pk_bf16_f32 v57, v48, v49
    ds_write_b32 v4, v57 offset:15232
    v_pk_mul_f32 v[30:31], v[32:33], v[26:27] op_sel:[1,1] op_sel_hi:[1,0] neg_lo:[1,0]
    v_pk_fma_f32 v[32:33], v[32:33], v[26:27], v[30:31] op_sel:[0,0,0] op_sel_hi:[0,1,1]
    v_cvt_pk_bf16_f32 v58, v32, v33
    ds_write_b32 v4, v58 offset:10336
    v_pk_mul_f32 v[30:31], v[32:33], v[26:27] op_sel:[1,1] op_sel_hi:[1,0] neg_lo:[1,0]
    v_pk_fma_f32 v[32:33], v[32:33], v[26:27], v[30:31] op_sel:[0,0,0] op_sel_hi:[0,1,1]
    v_cvt_pk_bf16_f32 v59, v32, v33
    ds_write_b32 v4, v59 offset:10608
    v_pk_mul_f32 v[30:31], v[32:33], v[26:27] op_sel:[1,1] op_sel_hi:[1,0] neg_lo:[1,0]
    v_pk_fma_f32 v[32:33], v[32:33], v[26:27], v[30:31] op_sel:[0,0,0] op_sel_hi:[0,1,1]
    v_cvt_pk_bf16_f32 v56, v32, v33
    ds_write_b32 v4, v56 offset:10880
    v_mov_b32 v60, 0
    v_mov_b32 v61, 0
    v_mov_b32 v62, 0
    v_mov_b32 v63, 0
    v_mov_b32 v64, 0
    v_mov_b32 v65, 0
    v_mov_b32 v66, 0
    v_mov_b32 v67, 0
    v_mov_b32 v68, 0
    v_mov_b32 v69, 0
    v_mov_b32 v70, 0
    v_mov_b32 v71, 0
    s_waitcnt lgkmcnt(0)
    ds_read_b128 v[72:75], v5 offset:11152
    ds_read_b128 v[76:79], v5 offset:0
    ds_read_b128 v[80:83], v5 offset:4352
    ds_read_b128 v[84:87], v5 offset:8704
    ds_read_b128 v[88:91], v5 offset:11216
    ds_read_b128 v[92:95], v5 offset:64
    ds_read_b128 v[96:99], v5 offset:4416
    ds_read_b128 v[100:103], v5 offset:8768
    s_waitcnt lgkmcnt(4)
    v_mfma_f32_16x16x32_bf16 v[60:63], v[76:79], v[72:75], v[60:63]
    v_mfma_f32_16x16x32_bf16 v[64:67], v[80:83], v[72:75], v[64:67]
    v_mfma_f32_16x16x32_bf16 v[68:71], v[84:87], v[72:75], v[68:71]
    s_waitcnt lgkmcnt(0)
    v_mfma_f32_16x16x32_bf16 v[60:63], v[92:95], v[88:91], v[60:63]
    v_mfma_f32_16x16x32_bf16 v[64:67], v[96:99], v[88:91], v[64:67]
    v_mfma_f32_16x16x32_bf16 v[68:71], v[100:103], v[88:91], v[68:71]
    ds_read_b128 v[72:75], v5 offset:11280
    ds_read_b128 v[76:79], v5 offset:128
    ds_read_b128 v[80:83], v5 offset:4480
    ds_read_b128 v[84:87], v5 offset:8832
    ds_read_b128 v[88:91], v5 offset:11344
    ds_read_b128 v[92:95], v5 offset:192
    ds_read_b128 v[96:99], v5 offset:4544
    ds_read_b128 v[100:103], v5 offset:8896
    s_waitcnt lgkmcnt(4)
    v_mfma_f32_16x16x32_bf16 v[60:63], v[76:79], v[72:75], v[60:63]
    v_mfma_f32_16x16x32_bf16 v[64:67], v[80:83], v[72:75], v[64:67]
    v_mfma_f32_16x16x32_bf16 v[68:71], v[84:87], v[72:75], v[68:71]
    s_waitcnt lgkmcnt(0)
    v_mfma_f32_16x16x32_bf16 v[60:63], v[92:95], v[88:91], v[60:63]
    v_mfma_f32_16x16x32_bf16 v[64:67], v[96:99], v[88:91], v[64:67]
    v_mfma_f32_16x16x32_bf16 v[68:71], v[100:103], v[88:91], v[68:71]
kgen1_skip:
ld_pro_done:
    s_cmp_eq_u32 s28, 7
    s_cbranch_scc1 ld_w7
    s_waitcnt vmcnt(1)
    s_barrier
    s_add_u32 s58, s56, 2
    s_cmp_ge_u32 s58, 10
    s_cselect_b32 s59, 10, 0
    s_sub_u32 s58, s58, s59
    s_lshl_b32 s33, s58, 7
    s_mul_i32 s34, s58, 221184
    s_add_u32 m0, s32, 81920
    s_add_u32 s31, s33, 0
    buffer_load_dwordx4 v15, s[8:11], s31 offen lds
    s_add_u32 m0, s32, 65536
    s_add_u32 s31, s34, 0
    buffer_load_dwordx4 v14, s[12:15], s31 offen lds
    s_add_u32 m0, s32, 86016
    s_add_u32 s31, s33, 40960
    buffer_load_dwordx4 v15, s[8:11], s31 offen lds
    s_add_u32 m0, s32, 69632
    s_add_u32 s31, s34, 55296
    buffer_load_dwordx4 v14, s[12:15], s31 offen lds
    s_add_u32 m0, s32, 90112
    s_add_u32 s31, s33, 81920
    buffer_load_dwordx4 v15, s[8:11], s31 offen lds
    s_add_u32 m0, s32, 73728
    s_add_u32 s31, s34, 110592
    buffer_load_dwordx4 v14, s[12:15], s31 offen lds
    s_add_u32 m0, s32, 94208
    s_add_u32 s31, s33, 122880
    buffer_load_dwordx4 v15, s[8:11], s31 offen lds
    s_add_u32 m0, s32, 77824
    s_add_u32 s31, s34, 165888
    buffer_load_dwordx4 v14, s[12:15], s31 offen lds
    s_waitcnt vmcnt(8)
    s_barrier
    s_add_u32 s58, s56, 3
    s_cmp_ge_u32 s58, 10
    s_cselect_b32 s59, 10, 0
    s_sub_u32 s58, s58, s59
    s_lshl_b32 s33, s58, 7
    s_mul_i32 s34, s58, 221184
    s_add_u32 m0, s32, 16384
    s_add_u32 s31, s33, 0
    buffer_load_dwordx4 v15, s[8:11], s31 offen lds
    s_add_u32 m0, s32, 0
    s_add_u32 s31, s34, 0
    buffer_load_dwordx4 v14, s[12:15], s31 offen lds
    s_add_u32 m0, s32, 20480
    s_add_u32 s31, s33, 40960
    buffer_load_dwordx4 v15, s[8:11], s31 offen lds
    s_add_u32 m0, s32, 4096
    s_add_u32 s31, s34, 55296
    buffer_load_dwordx4 v14, s[12:15], s31 offen lds
    s_add_u32 m0, s32, 24576
    s_add_u32 s31, s33, 81920
    buffer_load_dwordx4 v15, s[8:11], s31 offen lds
    s_add_u32 m0, s32, 8192
    s_add_u32 s31, s34, 110592
    buffer_load_dwordx4 v14, s[12:15], s31 offen lds
    s_add_u32 m0, s32, 28672
    s_add_u32 s31, s33, 122880
    buffer_load_dwordx4 v15, s[8:11], s31 offen lds
    s_add_u32 m0, s32, 12288
    s_add_u32 s31, s34, 165888
    buffer_load_dwordx4 v14, s[12:15], s31 offen lds
    s_waitcnt vmcnt(8)
    s_barrier
    s_add_u32 s58, s56, 4
    s_cmp_ge_u32 s58, 10
    s_cselect_b32 s59, 10, 0
    s_sub_u32 s58, s58, s59
    s_lshl_b32 s33, s58, 7
    s_mul_i32 s34, s58, 221184
    s_add_u32 m0, s32, 49152
    s_add_u32 s31, s33, 0
    buffer_load_dwordx4 v15, s[8:11], s31 offen lds
    s_add_u32 m0, s32, 32768
    s_add_u32 s31, s34, 0
    buffer_load_dwordx4 v14, s[12:15], s31 offen lds
    s_add_u32 m0, s32, 53248
    s_add_u32 s31, s33, 40960
    buffer_load_dwordx4 v15, s[8:11], s31 offen lds
    s_add_u32 m0, s32, 36864
    s_add_u32 s31, s34, 55296
    buffer_load_dwordx4 v14, s[12:15], s31 offen lds
    s_add_u32 m0, s32, 57344
    s_add_u32 s31, s33, 81920
    buffer_load_dwordx4 v15, s[8:11], s31 offen lds
    s_add_u32 m0, s32, 40960
    s_add_u32 s31, s34, 110592
    buffer_load_dwordx4 v14, s[12:15], s31 offen lds
    s_add_u32 m0, s32, 61440
    s_add_u32 s31, s33, 122880
    buffer_load_dwordx4 v15, s[8:11], s31 offen lds
    s_add_u32 m0, s32, 45056
    s_add_u32 s31, s34, 165888
    buffer_load_dwordx4 v14, s[12:15], s31 offen lds
    s_waitcnt vmcnt(8)
    s_barrier
    s_add_u32 s58, s56, 5
    s_cmp_ge_u32 s58, 10
    s_cselect_b32 s59, 10, 0
    s_sub_u32 s58, s58, s59
    s_lshl_b32 s33, s58, 7
    s_mul_i32 s34, s58, 221184
    s_add_u32 m0, s32, 81920
    s_add_u32 s31, s33, 0
    buffer_load_dwordx4 v15, s[8:11], s31 offen lds
    s_add_u32 m0, s32, 65536
    s_add_u32 s31, s34, 0
    buffer_load_dwordx4 v14, s[12:15], s31 offen lds
    s_add_u32 m0, s32, 86016
    s_add_u32 s31, s33, 40960
    buffer_load_dwordx4 v15, s[8:11], s31 offen lds
    s_add_u32 m0, s32, 69632
    s_add_u32 s31, s34, 55296
    buffer_load_dwordx4 v14, s[12:15], s31 offen lds
    s_add_u32 m0, s32, 90112
    s_add_u32 s31, s33, 81920
    buffer_load_dwordx4 v15, s[8:11], s31 offen lds
    s_add_u32 m0, s32, 73728
    s_add_u32 s31, s34, 110592
    buffer_load_dwordx4 v14, s[12:15], s31 offen lds
    s_add_u32 m0, s32, 94208
    s_add_u32 s31, s33, 122880
    buffer_load_dwordx4 v15, s[8:11], s31 offen lds
    s_add_u32 m0, s32, 77824
    s_add_u32 s31, s34, 165888
    buffer_load_dwordx4 v14, s[12:15], s31 offen lds
    s_waitcnt vmcnt(8)
    s_barrier
    s_add_u32 s58, s56, 6
    s_cmp_ge_u32 s58, 10
    s_cselect_b32 s59, 10, 0
    s_sub_u32 s58, s58, s59
    s_lshl_b32 s33, s58, 7
    s_mul_i32 s34, s58, 221184
    s_add_u32 m0, s32, 16384
    s_add_u32 s31, s33, 0
    buffer_load_dwordx4 v15, s[8:11], s31 offen lds
    s_add_u32 m0, s32, 0
    s_add_u32 s31, s34, 0
    buffer_load_dwordx4 v14, s[12:15], s31 offen lds
    s_add_u32 m0, s32, 20480
    s_add_u32 s31, s33, 40960
    buffer_load_dwordx4 v15, s[8:11], s31 offen lds
    s_add_u32 m0, s32, 4096
    s_add_u32 s31, s34, 55296
    buffer_load_dwordx4 v14, s[12:15], s31 offen lds
    s_add_u32 m0, s32, 24576
    s_add_u32 s31, s33, 81920
    buffer_load_dwordx4 v15, s[8:11], s31 offen lds
    s_add_u32 m0, s32, 8192
    s_add_u32 s31, s34, 110592
    buffer_load_dwordx4 v14, s[12:15], s31 offen lds
    s_add_u32 m0, s32, 28672
    s_add_u32 s31, s33, 122880
    buffer_load_dwordx4 v15, s[8:11], s31 offen lds
    s_add_u32 m0, s32, 12288
    s_add_u32 s31, s34, 165888
    buffer_load_dwordx4 v14, s[12:15], s31 offen lds
    s_waitcnt vmcnt(8)
    s_barrier
    s_add_u32 s58, s56, 7
    s_cmp_ge_u32 s58, 10
    s_cselect_b32 s59, 10, 0
    s_sub_u32 s58, s58, s59
    s_lshl_b32 s33, s58, 7
    s_mul_i32 s34, s58, 221184
    s_add_u32 m0, s32, 49152
    s_add_u32 s31, s33, 0
    buffer_load_dwordx4 v15, s[8:11], s31 offen lds
    s_add_u32 m0, s32, 32768
    s_add_u32 s31, s34, 0
    buffer_load_dwordx4 v14, s[12:15], s31 offen lds
    s_add_u32 m0, s32, 53248
    s_add_u32 s31, s33, 40960
    buffer_load_dwordx4 v15, s[8:11], s31 offen lds
    s_add_u32 m0, s32, 36864
    s_add_u32 s31, s34, 55296
    buffer_load_dwordx4 v14, s[12:15], s31 offen lds
    s_add_u32 m0, s32, 57344
    s_add_u32 s31, s33, 81920
    buffer_load_dwordx4 v15, s[8:11], s31 offen lds
    s_add_u32 m0, s32, 40960
    s_add_u32 s31, s34, 110592
    buffer_load_dwordx4 v14, s[12:15], s31 offen lds
    s_add_u32 m0, s32, 61440
    s_add_u32 s31, s33, 122880
    buffer_load_dwordx4 v15, s[8:11], s31 offen lds
    s_add_u32 m0, s32, 45056
    s_add_u32 s31, s34, 165888
    buffer_load_dwordx4 v14, s[12:15], s31 offen lds
    s_waitcnt vmcnt(8)
    s_barrier
    s_add_u32 s58, s56, 8
    s_cmp_ge_u32 s58, 10
    s_cselect_b32 s59, 10, 0
    s_sub_u32 s58, s58, s59
    s_lshl_b32 s33, s58, 7
    s_mul_i32 s34, s58, 221184
    s_add_u32 m0, s32, 81920
    s_add_u32 s31, s33, 0
    buffer_load_dwordx4 v15, s[8:11], s31 offen lds
    s_add_u32 m0, s32, 65536
    s_add_u32 s31, s34, 0
    buffer_load_dwordx4 v14, s[12:15], s31 offen lds
    s_add_u32 m0, s32, 86016
    s_add_u32 s31, s33, 40960
    buffer_load_dwordx4 v15, s[8:11], s31 offen lds
    s_add_u32 m0, s32, 69632
    s_add_u32 s31, s34, 55296
    buffer_load_dwordx4 v14, s[12:15], s31 offen lds
    s_add_u32 m0, s32, 90112
    s_add_u32 s31, s33, 81920
    buffer_load_dwordx4 v15, s[8:11], s31 offen lds
    s_add_u32 m0, s32, 73728
    s_add_u32 s31, s34, 110592
    buffer_load_dwordx4 v14, s[12:15], s31 offen lds
    s_add_u32 m0, s32, 94208
    s_add_u32 s31, s33, 122880
    buffer_load_dwordx4 v15, s[8:11], s31 offen lds
    s_add_u32 m0, s32, 77824
    s_add_u32 s31, s34, 165888
    buffer_load_dwordx4 v14, s[12:15], s31 offen lds
    s_waitcnt vmcnt(8)
    s_barrier
    s_add_u32 s58, s56, 9
    s_cmp_ge_u32 s58, 10
    s_cselect_b32 s59, 10, 0
    s_sub_u32 s58, s58, s59
    s_lshl_b32 s33, s58, 7
    s_mul_i32 s34, s58, 221184
    s_add_u32 m0, s32, 16384
    s_add_u32 s31, s33, 0
    buffer_load_dwordx4 v15, s[8:11], s31 offen lds
    s_add_u32 m0, s32, 0
    s_add_u32 s31, s34, 0
    buffer_load_dwordx4 v14, s[12:15], s31 offen lds
    s_add_u32 m0, s32, 20480
    s_add_u32 s31, s33, 40960
    buffer_load_dwordx4 v15, s[8:11], s31 offen lds
    s_add_u32 m0, s32, 4096
    s_add_u32 s31, s34, 55296
    buffer_load_dwordx4 v14, s[12:15], s31 offen lds
    s_add_u32 m0, s32, 24576
    s_add_u32 s31, s33, 81920
    buffer_load_dwordx4 v15, s[8:11], s31 offen lds
    s_add_u32 m0, s32, 8192
    s_add_u32 s31, s34, 110592
    buffer_load_dwordx4 v14, s[12:15], s31 offen lds
    s_add_u32 m0, s32, 28672
    s_add_u32 s31, s33, 122880
    buffer_load_dwordx4 v15, s[8:11], s31 offen lds
    s_add_u32 m0, s32, 12288
    s_add_u32 s31, s34, 165888
    buffer_load_dwordx4 v14, s[12:15], s31 offen lds
    s_waitcnt vmcnt(8)
    s_barrier
    s_waitcnt vmcnt(0)
    s_barrier
    s_barrier
    v_readfirstlane_b32 s60, v140
    s_nop 3
    s_cmp_lg_u32 s60, 0
    s_cbranch_scc1 nonce_ok4
    s_mov_b32 s4, s90
    s_and_b32 s5, s91, 0xffff
    s_mov_b32 s6, 256
    s_mov_b32 s7, 0x00020000
    s_mov_b32 s61, 0
    v_mov_b32 v141, 0
nonce_spin4:
    buffer_load_dword v140, v141, s[4:7], 0 offen sc1
    s_waitcnt vmcnt(0)
    v_readfirstlane_b32 s60, v140
    s_nop 3
    s_cmp_lg_u32 s60, 0
    s_cbranch_scc1 nonce_ok4
    s_sleep 1
    s_add_u32 s61, s61, 1
    s_cmp_lt_u32 s61, 0x8000
    s_cbranch_scc1 nonce_spin4
nonce_ok4:
    s_cmp_eq_u32 s47, 0
    s_cbranch_scc1 k_done
    s_setprio 0
    s_and_b32 s30, s28, 3
    s_mul_i32 s30, s30, 16128
    s_add_u32 s30, s30, 98304
    v_mov_b32 v2, s30
    v_lshl_add_u32 v4, v1, 4, v2
    ds_read_b128 v[72:75], v4 offset:11392
    ds_read_b128 v[76:79], v4 offset:12416
    ds_read_b128 v[80:83], v4 offset:13440
    s_waitcnt lgkmcnt(0)
    v_add_f32 v60, v60, v72
    v_add_f32 v61, v61, v73
    v_add_f32 v62, v62, v74
    v_add_f32 v63, v63, v75
    v_add_f32 v64, v64, v76
    v_add_f32 v65, v65, v77
    v_add_f32 v66, v66, v78
    v_add_f32 v67, v67, v79
    v_add_f32 v68, v68, v80
    v_add_f32 v69, v69, v81
    v_add_f32 v70, v70, v82
    v_add_f32 v71, v71, v83
    v_cvt_pk_bf16_f32 v60, v60, v60
    v_cvt_pk_bf16_f32 v61, v61, v61
    v_cvt_pk_bf16_f32 v62, v62, v62
    v_cvt_pk_bf16_f32 v63, v63, v63
    v_cvt_pk_bf16_f32 v64, v64, v64
    v_cvt_pk_bf16_f32 v65, v65, v65
    v_cvt_pk_bf16_f32 v66, v66, v66
    v_cvt_pk_bf16_f32 v67, v67, v67
    v_cvt_pk_bf16_f32 v68, v68, v68
    v_cvt_pk_bf16_f32 v69, v69, v69
    v_cvt_pk_bf16_f32 v70, v70, v70
    v_cvt_pk_bf16_f32 v71, v71, v71
    v_and_b32 v6, 15, v1
    v_lshrrev_b32 v7, 4, v1
    v_lshlrev_b32 v8, 3, v6
    v_and_b32 v9, 1, v7
    v_lshl_add_u32 v8, v9, 2, v8
    v_lshrrev_b32 v9, 1, v7
    v_lshl_add_u32 v8, v9, 7, v8
    v_lshl_add_u32 v8, v8, 2, v2
    ds_write_b128 v8, v[60:63] offset:0
    v_cmp_gt_u32 vcc, 2, v7
    v_lshlrev_b32 v8, 2, v6
    v_lshlrev_b32 v9, 1, v6
    v_cndmask_b32 v8, v9, v8, vcc
    v_lshl_add_u32 v8, v7, 6, v8
    v_lshl_add_u32 v8, v8, 2, v2
    v_mov_b32 v9, 128
    v_cndmask_b32 v9, v9, 8, vcc
    v_add_u32 v9, v8, v9
    ds_write_b64 v8, v[64:65] offset:1024
    ds_write_b64 v9, v[66:67] offset:1024
    v_lshl_add_u32 v8, v7, 6, v6
    v_lshl_add_u32 v8, v8, 2, v2
    ds_write_b32 v8, v68 offset:2048
    ds_write_b32 v8, v69 offset:2112
    ds_write_b32 v8, v70 offset:2176
    ds_write_b32 v8, v71 offset:2240
    s_mov_b32 s26, 0xffff
    v_lshl_add_u32 v9, v1, 4, v2
    s_waitcnt lgkmcnt(0)
    v_lshl_add_u32 v8, v1, 5, v2
    s_mov_b32 exec_lo, -1
    s_mov_b32 exec_hi, 0
    ds_read_b32 v72, v8 offset:0
    ds_read_b32 v73, v8 offset:4
    ds_read_b32 v74, v8 offset:8
    ds_read_b32 v75, v8 offset:12
    ds_read_b32 v76, v8 offset:16
    ds_read_b32 v77, v8 offset:20
    ds_read_b32 v78, v8 offset:24
    ds_read_b32 v79, v8 offset:28
    ds_read_b32 v80, v8 offset:32
    s_mov_b32 exec_lo, 0
    s_mov_b32 exec_hi, -1
    v_lshl_add_u32 v8, v1, 4, v2
    ds_read_b32 v72, v8 offset:512
    ds_read_b32 v73, v8 offset:512
    ds_read_b32 v74, v8 offset:516
    ds_read_b32 v75, v8 offset:520
    ds_read_b32 v76, v8 offset:520
    ds_read_b32 v77, v8 offset:520
    ds_read_b32 v78, v8 offset:524
    ds_read_b32 v79, v8 offset:528
    ds_read_b32 v80, v8 offset:528
    s_mov_b64 exec, -1
    v_lshl_add_u32 v8, v1, 3, v2
    ds_read_b64 v[96:97], v8 offset:1536
    ds_read_b32 v98, v8 offset:1544
    v_lshl_add_u32 v8, v1, 2, v2
    v_add_u32 v8, 2048, v8
    ds_read2_b32 v[100:101], v8 offset0:0 offset1:1
    ds_read2_b32 v[102:103], v8 offset0:64 offset1:65
    s_waitcnt lgkmcnt(0)
    v_bfi_b32 v84, s26, v72, v73
    v_bfi_b32 v88, s26, v73, v74
    v_bfi_b32 v85, s26, v74, v75
    v_bfi_b32 v89, s26, v75, v76
    v_bfi_b32 v86, s26, v76, v77
    v_bfi_b32 v90, s26, v77, v78
    v_bfi_b32 v87, s26, v78, v79
    v_bfi_b32 v91, s26, v79, v80
    ds_write_b128 v9, v[84:87] offset:3104
    ds_write_b128 v9, v[88:91] offset:7264
    v_mov_b32 v104, v96
    v_bfi_b32 v105, s26, v96, v97
    v_mov_b32 v106, v97
    v_mov_b32 v107, v98
    v_mov_b32 v108, v96
    v_mov_b32 v109, v97
    v_bfi_b32 v110, s26, v97, v98
    v_mov_b32 v111, v98
    ds_write_b128 v9, v[104:107] offset:4128
    ds_write_b128 v9, v[108:111] offset:8288
    v_and_b32 v8, 1, v1
    v_cmp_eq_u32 vcc, 0, v8
    v_bfi_b32 v8, s26, v100, v101
    v_mov_b32 v112, v100
    v_mov_b32 v113, v100
    v_cndmask_b32 v114, v101, v8, vcc
    v_mov_b32 v115, v101
    v_mov_b32 v116, v100
    v_cndmask_b32 v117, v8, v100, vcc
    v_mov_b32 v118, v101
    v_mov_b32 v119, v101
    ds_write_b128 v9, v[112:115] offset:5152
    ds_write_b128 v9, v[116:119] offset:9312
    v_bfi_b32 v8, s26, v102, v103
    v_mov_b32 v120, v102
    v_mov_b32 v121, v102
    v_cndmask_b32 v122, v103, v8, vcc
    v_mov_b32 v123, v103
    v_mov_b32 v124, v102
    v_cndmask_b32 v125, v8, v102, vcc
    v_mov_b32 v126, v103
    v_mov_b32 v127, v103
    ds_write_b128 v9, v[120:123] offset:6176
    ds_write_b128 v9, v[124:127] offset:10336
    v_mov_b32 v84, 0
    v_mov_b32 v85, 0
    v_mov_b32 v86, 0
    v_mov_b32 v87, 0
    v_and_b32 v88, 0xffff0000, v72
    v_mov_b32 v89, 0
    s_mov_b64 exec, 1
    ds_write_b128 v2, v[84:87] offset:3072
    ds_write_b128 v2, v[84:87] offset:3088
    ds_write_b128 v2, v[84:87] offset:7232
    v_mov_b32 v87, v88
    ds_write_b128 v2, v[84:87] offset:7248
    s_mov_b64 exec, -1
    s_branch conv_go
ld_w7:
    s_waitcnt vmcnt(32)
    s_barrier
    s_add_u32 s58, s56, 2
    s_cmp_ge_u32 s58, 10
    s_cselect_b32 s59, 10, 0
    s_sub_u32 s58, s58, s59
    s_lshl_b32 s33, s58, 7
    s_mul_i32 s34, s58, 221184
    s_add_u32 m0, s32, 81920
    s_add_u32 s31, s33, 0
    buffer_load_dwordx4 v15, s[8:11], s31 offen lds
    s_add_u32 m0, s32, 65536
    s_add_u32 s31, s34, 0
    buffer_load_dwordx4 v14, s[12:15], s31 offen lds
    s_add_u32 m0, s32, 86016
    s_add_u32 s31, s33, 40960
    buffer_load_dwordx4 v15, s[8:11], s31 offen lds
    s_add_u32 m0, s32, 69632
    s_add_u32 s31, s34, 55296
    buffer_load_dwordx4 v14, s[12:15], s31 offen lds
    s_add_u32 m0, s32, 90112
    s_add_u32 s31, s33, 81920
    buffer_load_dwordx4 v15, s[8:11], s31 offen lds
    s_add_u32 m0, s32, 73728
    s_add_u32 s31, s34, 110592
    buffer_load_dwordx4 v14, s[12:15], s31 offen lds
    s_add_u32 m0, s32, 94208
    s_add_u32 s31, s33, 122880
    buffer_load_dwordx4 v15, s[8:11], s31 offen lds
    s_add_u32 m0, s32, 77824
    s_add_u32 s31, s34, 165888
    buffer_load_dwordx4 v14, s[12:15], s31 offen lds
    s_waitcnt vmcnt(8)
    s_barrier
    s_add_u32 s58, s56, 3
    s_cmp_ge_u32 s58, 10
    s_cselect_b32 s59, 10, 0
    s_sub_u32 s58, s58, s59
    s_lshl_b32 s33, s58, 7
    s_mul_i32 s34, s58, 221184
    s_add_u32 m0, s32, 16384
    s_add_u32 s31, s33, 0
    buffer_load_dwordx4 v15, s[8:11], s31 offen lds
    s_add_u32 m0, s32, 0
    s_add_u32 s31, s34, 0
    buffer_load_dwordx4 v14, s[12:15], s31 offen lds
    s_add_u32 m0, s32, 20480
    s_add_u32 s31, s33, 40960
    buffer_load_dwordx4 v15, s[8:11], s31 offen lds
    s_add_u32 m0, s32, 4096
    s_add_u32 s31, s34, 55296
    buffer_load_dwordx4 v14, s[12:15], s31 offen lds
    s_add_u32 m0, s32, 24576
    s_add_u32 s31, s33, 81920
    buffer_load_dwordx4 v15, s[8:11], s31 offen lds
    s_add_u32 m0, s32, 8192
    s_add_u32 s31, s34, 110592
    buffer_load_dwordx4 v14, s[12:15], s31 offen lds
    s_add_u32 m0, s32, 28672
    s_add_u32 s31, s33, 122880
    buffer_load_dwordx4 v15, s[8:11], s31 offen lds
    s_add_u32 m0, s32, 12288
    s_add_u32 s31, s34, 165888
    buffer_load_dwordx4 v14, s[12:15], s31 offen lds
    s_waitcnt vmcnt(8)
    s_barrier
    s_add_u32 s58, s56, 4
    s_cmp_ge_u32 s58, 10
    s_cselect_b32 s59, 10, 0
    s_sub_u32 s58, s58, s59
    s_lshl_b32 s33, s58, 7
    s_mul_i32 s34, s58, 221184
    s_add_u32 m0, s32, 49152
    s_add_u32 s31, s33, 0
    buffer_load_dwordx4 v15, s[8:11], s31 offen lds
    s_add_u32 m0, s32, 32768
    s_add_u32 s31, s34, 0
    buffer_load_dwordx4 v14, s[12:15], s31 offen lds
    s_add_u32 m0, s32, 53248
    s_add_u32 s31, s33, 40960
    buffer_load_dwordx4 v15, s[8:11], s31 offen lds
    s_add_u32 m0, s32, 36864
    s_add_u32 s31, s34, 55296
    buffer_load_dwordx4 v14, s[12:15], s31 offen lds
    s_add_u32 m0, s32, 57344
    s_add_u32 s31, s33, 81920
    buffer_load_dwordx4 v15, s[8:11], s31 offen lds
    s_add_u32 m0, s32, 40960
    s_add_u32 s31, s34, 110592
    buffer_load_dwordx4 v14, s[12:15], s31 offen lds
    s_add_u32 m0, s32, 61440
    s_add_u32 s31, s33, 122880
    buffer_load_dwordx4 v15, s[8:11], s31 offen lds
    s_add_u32 m0, s32, 45056
    s_add_u32 s31, s34, 165888
    buffer_load_dwordx4 v14, s[12:15], s31 offen lds
    s_waitcnt vmcnt(8)
    s_barrier
    s_add_u32 s58, s56, 5
    s_cmp_ge_u32 s58, 10
    s_cselect_b32 s59, 10, 0
    s_sub_u32 s58, s58, s59
    s_lshl_b32 s33, s58, 7
    s_mul_i32 s34, s58, 221184
    s_add_u32 m0, s32, 81920
    s_add_u32 s31, s33, 0
    buffer_load_dwordx4 v15, s[8:11], s31 offen lds
    s_add_u32 m0, s32, 65536
    s_add_u32 s31, s34, 0
    buffer_load_dwordx4 v14, s[12:15], s31 offen lds
    s_add_u32 m0, s32, 86016
    s_add_u32 s31, s33, 40960
    buffer_load_dwordx4 v15, s[8:11], s31 offen lds
    s_add_u32 m0, s32, 69632
    s_add_u32 s31, s34, 55296
    buffer_load_dwordx4 v14, s[12:15], s31 offen lds
    s_add_u32 m0, s32, 90112
    s_add_u32 s31, s33, 81920
    buffer_load_dwordx4 v15, s[8:11], s31 offen lds
    s_add_u32 m0, s32, 73728
    s_add_u32 s31, s34, 110592
    buffer_load_dwordx4 v14, s[12:15], s31 offen lds
    s_add_u32 m0, s32, 94208
    s_add_u32 s31, s33, 122880
    buffer_load_dwordx4 v15, s[8:11], s31 offen lds
    s_add_u32 m0, s32, 77824
    s_add_u32 s31, s34, 165888
    buffer_load_dwordx4 v14, s[12:15], s31 offen lds
    s_waitcnt vmcnt(8)
    s_barrier
    s_add_u32 s58, s56, 6
    s_cmp_ge_u32 s58, 10
    s_cselect_b32 s59, 10, 0
    s_sub_u32 s58, s58, s59
    s_lshl_b32 s33, s58, 7
    s_mul_i32 s34, s58, 221184
    s_add_u32 m0, s32, 16384
    s_add_u32 s31, s33, 0
    buffer_load_dwordx4 v15, s[8:11], s31 offen lds
    s_add_u32 m0, s32, 0
    s_add_u32 s31, s34, 0
    buffer_load_dwordx4 v14, s[12:15], s31 offen lds
    s_add_u32 m0, s32, 20480
    s_add_u32 s31, s33, 40960
    buffer_load_dwordx4 v15, s[8:11], s31 offen lds
    s_add_u32 m0, s32, 4096
    s_add_u32 s31, s34, 55296
    buffer_load_dwordx4 v14, s[12:15], s31 offen lds
    s_add_u32 m0, s32, 24576
    s_add_u32 s31, s33, 81920
    buffer_load_dwordx4 v15, s[8:11], s31 offen lds
    s_add_u32 m0, s32, 8192
    s_add_u32 s31, s34, 110592
    buffer_load_dwordx4 v14, s[12:15], s31 offen lds
    s_add_u32 m0, s32, 28672
    s_add_u32 s31, s33, 122880
    buffer_load_dwordx4 v15, s[8:11], s31 offen lds
    s_add_u32 m0, s32, 12288
    s_add_u32 s31, s34, 165888
    buffer_load_dwordx4 v14, s[12:15], s31 offen lds
    s_waitcnt vmcnt(8)
    s_barrier
    s_add_u32 s58, s56, 7
    s_cmp_ge_u32 s58, 10
    s_cselect_b32 s59, 10, 0
    s_sub_u32 s58, s58, s59
    s_lshl_b32 s33, s58, 7
    s_mul_i32 s34, s58, 221184
    s_add_u32 m0, s32, 49152
    s_add_u32 s31, s33, 0
    buffer_load_dwordx4 v15, s[8:11], s31 offen lds
    s_add_u32 m0, s32, 32768
    s_add_u32 s31, s34, 0
    buffer_load_dwordx4 v14, s[12:15], s31 offen lds
    s_add_u32 m0, s32, 53248
    s_add_u32 s31, s33, 40960
    buffer_load_dwordx4 v15, s[8:11], s31 offen lds
    s_add_u32 m0, s32, 36864
    s_add_u32 s31, s34, 55296
    buffer_load_dwordx4 v14, s[12:15], s31 offen lds
    s_add_u32 m0, s32, 57344
    s_add_u32 s31, s33, 81920
    buffer_load_dwordx4 v15, s[8:11], s31 offen lds
    s_add_u32 m0, s32, 40960
    s_add_u32 s31, s34, 110592
    buffer_load_dwordx4 v14, s[12:15], s31 offen lds
    s_add_u32 m0, s32, 61440
    s_add_u32 s31, s33, 122880
    buffer_load_dwordx4 v15, s[8:11], s31 offen lds
    s_add_u32 m0, s32, 45056
    s_add_u32 s31, s34, 165888
    buffer_load_dwordx4 v14, s[12:15], s31 offen lds
    s_waitcnt vmcnt(8)
    s_barrier
    s_add_u32 s58, s56, 8
    s_cmp_ge_u32 s58, 10
    s_cselect_b32 s59, 10, 0
    s_sub_u32 s58, s58, s59
    s_lshl_b32 s33, s58, 7
    s_mul_i32 s34, s58, 221184
    s_add_u32 m0, s32, 81920
    s_add_u32 s31, s33, 0
    buffer_load_dwordx4 v15, s[8:11], s31 offen lds
    s_add_u32 m0, s32, 65536
    s_add_u32 s31, s34, 0
    buffer_load_dwordx4 v14, s[12:15], s31 offen lds
    s_add_u32 m0, s32, 86016
    s_add_u32 s31, s33, 40960
    buffer_load_dwordx4 v15, s[8:11], s31 offen lds
    s_add_u32 m0, s32, 69632
    s_add_u32 s31, s34, 55296
    buffer_load_dwordx4 v14, s[12:15], s31 offen lds
    s_add_u32 m0, s32, 90112
    s_add_u32 s31, s33, 81920
    buffer_load_dwordx4 v15, s[8:11], s31 offen lds
    s_add_u32 m0, s32, 73728
    s_add_u32 s31, s34, 110592
    buffer_load_dwordx4 v14, s[12:15], s31 offen lds
    s_add_u32 m0, s32, 94208
    s_add_u32 s31, s33, 122880
    buffer_load_dwordx4 v15, s[8:11], s31 offen lds
    s_add_u32 m0, s32, 77824
    s_add_u32 s31, s34, 165888
    buffer_load_dwordx4 v14, s[12:15], s31 offen lds
    s_waitcnt vmcnt(8)
    s_barrier
    s_add_u32 s58, s56, 9
    s_cmp_ge_u32 s58, 10
    s_cselect_b32 s59, 10, 0
    s_sub_u32 s58, s58, s59
    s_lshl_b32 s33, s58, 7
    s_mul_i32 s34, s58, 221184
    s_add_u32 m0, s32, 16384
    s_add_u32 s31, s33, 0
    buffer_load_dwordx4 v15, s[8:11], s31 offen lds
    s_add_u32 m0, s32, 0
    s_add_u32 s31, s34, 0
    buffer_load_dwordx4 v14, s[12:15], s31 offen lds
    s_add_u32 m0, s32, 20480
    s_add_u32 s31, s33, 40960
    buffer_load_dwordx4 v15, s[8:11], s31 offen lds
    s_add_u32 m0, s32, 4096
    s_add_u32 s31, s34, 55296
    buffer_load_dwordx4 v14, s[12:15], s31 offen lds
    s_add_u32 m0, s32, 24576
    s_add_u32 s31, s33, 81920
    buffer_load_dwordx4 v15, s[8:11], s31 offen lds
    s_add_u32 m0, s32, 8192
    s_add_u32 s31, s34, 110592
    buffer_load_dwordx4 v14, s[12:15], s31 offen lds
    s_add_u32 m0, s32, 28672
    s_add_u32 s31, s33, 122880
    buffer_load_dwordx4 v15, s[8:11], s31 offen lds
    s_add_u32 m0, s32, 12288
    s_add_u32 s31, s34, 165888
    buffer_load_dwordx4 v14, s[12:15], s31 offen lds
    s_waitcnt vmcnt(8)
    s_barrier
    s_waitcnt vmcnt(0)
    s_barrier
    s_barrier
    v_readfirstlane_b32 s60, v140
    s_nop 3
    s_cmp_lg_u32 s60, 0
    s_cbranch_scc1 nonce_ok5
    s_mov_b32 s4, s90
    s_and_b32 s5, s91, 0xffff
    s_mov_b32 s6, 256
    s_mov_b32 s7, 0x00020000
    s_mov_b32 s61, 0
    v_mov_b32 v141, 0
nonce_spin5:
    buffer_load_dword v140, v141, s[4:7], 0 offen sc1
    s_waitcnt vmcnt(0)
    v_readfirstlane_b32 s60, v140
    s_nop 3
    s_cmp_lg_u32 s60, 0
    s_cbranch_scc1 nonce_ok5
    s_sleep 1
    s_add_u32 s61, s61, 1
    s_cmp_lt_u32 s61, 0x8000
    s_cbranch_scc1 nonce_spin5
nonce_ok5:
    v_mov_b32 v240, 163776
gate6:
    ds_read_b128 v[244:247], v240
    s_waitcnt lgkmcnt(0)
    v_and_b32 v244, v244, v245
    v_and_b32 v246, v246, v247
    v_and_b32 v244, v244, v246
    s_nop 0
    v_readfirstlane_b32 s30, v244
    s_nop 3
    s_cmp_eq_u32 s30, 1
    s_cbranch_scc1 gate_ok6
    s_sleep 2
    s_branch gate6
gate_ok6:
    s_branch poll_role
conv_go:
    v_lshlrev_b32 v240, 2, v1
    v_add_u32 v240, 15728640, v240
    v_cmp_gt_u32 vcc, 32, v1
    s_nop 3
    s_and_saveexec_b64 s[62:63], vcc
    s_mov_b32 s61, 0
pl_spin7:
    buffer_load_dword v242, v240, s[16:19], 0 offen sc1
    s_waitcnt vmcnt(0)
    v_cmp_ne_u32 vcc, s60, v242
    s_nop 3
    s_cbranch_vccz pl_ok7
    s_sleep 10
    s_add_u32 s61, s61, 1
    s_cmp_lt_u32 s61, 0x8000
    s_cbranch_scc1 pl_spin7
pl_ok7:
    s_mov_b64 exec, s[62:63]
    s_mul_i32 s20, s46, 4224
    s_add_u32 s21, s20, 0
    v_lshlrev_b32 v3, 4, v1
    buffer_load_dwordx4 v[64:67], v3, s[16:19], s21 offen offset:0 sc1
    buffer_load_dwordx4 v[68:71], v3, s[16:19], s21 offen offset:1024 sc1
    buffer_load_dwordx4 v[72:75], v3, s[16:19], s21 offen offset:2048 sc1
    buffer_load_dwordx4 v[76:79], v3, s[16:19], s21 offen offset:3072 sc1
    v_add_u32 v4, v3, v2
    v_mov_b32 v80, 0
    v_mov_b32 v81, 0
    v_mov_b32 v82, 0
    v_mov_b32 v83, 0
    s_mov_b32 exec_lo, 0x7fffffff
    s_mov_b32 exec_hi, 0
    ds_write_b128 v4, v[80:83] offset:15488
    s_mov_b64 exec, -1
    v_and_b32 v5, 15, v1
    v_lshrrev_b32 v6, 4, v1
    v_add_u32 v7, 1, v5
    v_lshrrev_b32 v7, 1, v7
    v_lshlrev_b32 v8, 2, v6
    v_sub_u32 v7, v7, v8
    v_add_u32 v7, 12, v7
    v_lshlrev_b32 v7, 2, v7
    v_and_b32 v8, 1, v5
    v_cmp_eq_u32 vcc, 1, v8
    v_mov_b32 v8, 7232
    v_mov_b32 v9, 3072
    v_cndmask_b32 v8, v8, v9, vcc
    v_add3_u32 v224, v7, v8, v2
    v_add_u32 v225, 512, v224
    v_add_u32 v226, 1024, v224
    v_add_u32 v227, 1536, v224
    v_add_u32 v228, 2048, v224
    v_add_u32 v229, 2560, v224
    v_add_u32 v230, 3072, v224
    v_add_u32 v231, 3584, v224
    v_lshlrev_b32 v7, 5, v5
    v_lshl_add_u32 v7, v6, 4, v7
    v_sub_u32 v7, 11920, v7
    v_add_u32 v232, v7, v2
    v_mov_b32 v128, 0
    v_mov_b32 v129, 0
    v_mov_b32 v130, 0
    v_mov_b32 v131, 0
    v_mov_b32 v132, 0
    v_mov_b32 v133, 0
    v_mov_b32 v134, 0
    v_mov_b32 v135, 0
    v_mov_b32 v136, 0
    v_mov_b32 v137, 0
    v_mov_b32 v138, 0
    v_mov_b32 v139, 0
    v_mov_b32 v140, 0
    v_mov_b32 v141, 0
    v_mov_b32 v142, 0
    v_mov_b32 v143, 0
    v_mov_b32 v144, 0
    v_mov_b32 v145, 0
    v_mov_b32 v146, 0
    v_mov_b32 v147, 0
    v_mov_b32 v148, 0
    v_mov_b32 v149, 0
    v_mov_b32 v150, 0
    v_mov_b32 v151, 0
    v_mov_b32 v152, 0
    v_mov_b32 v153, 0
    v_mov_b32 v154, 0
    v_mov_b32 v155, 0
    v_mov_b32 v156, 0
    v_mov_b32 v157, 0
    v_mov_b32 v158, 0
    v_mov_b32 v159, 0
    s_waitcnt vmcnt(0)
    ds_write_b128 v4, v[64:67] offset:11392
    ds_write_b128 v4, v[68:71] offset:12416
    ds_write_b128 v4, v[72:75] offset:13440
    ds_write_b128 v4, v[76:79] offset:14464
    s_waitcnt lgkmcnt(0)
    v_mov_b32 v240, 163776
gate8:
    ds_read_b128 v[244:247], v240
    s_waitcnt lgkmcnt(0)
    v_and_b32 v244, v244, v245
    v_and_b32 v246, v246, v247
    v_and_b32 v244, v244, v246
    s_nop 0
    v_readfirstlane_b32 s30, v244
    s_nop 3
    s_cmp_eq_u32 s30, 1
    s_cbranch_scc1 gate_ok8
    s_sleep 2
    s_branch gate8
gate_ok8:
    s_setprio 3
    ds_read2_b32 v[64:65], v224 offset0:0 offset1:1
    ds_read2_b32 v[66:67], v224 offset0:2 offset1:3
    ds_read_b128 v[160:163], v232 offset:3584
    ds_read2_b32 v[68:69], v225 offset0:0 offset1:1
    ds_read2_b32 v[70:71], v225 offset0:2 offset1:3
    ds_read_b128 v[164:167], v232 offset:3072
    ds_read2_b32 v[72:73], v226 offset0:0 offset1:1
    ds_read2_b32 v[74:75], v226 offset0:2 offset1:3
    ds_read_b128 v[168:171], v232 offset:2560
    ds_read2_b32 v[76:77], v227 offset0:0 offset1:1
    ds_read2_b32 v[78:79], v227 offset0:2 offset1:3
    ds_read_b128 v[172:175], v232 offset:2048
    ds_read2_b32 v[80:81], v228 offset0:0 offset1:1
    ds_read2_b32 v[82:83], v228 offset0:2 offset1:3
    ds_read_b128 v[176:179], v232 offset:1536
    ds_read2_b32 v[84:85], v229 offset0:0 offset1:1
    ds_read2_b32 v[86:87], v229 offset0:2 offset1:3
    ds_read_b128 v[180:183], v232 offset:1024
    ds_read2_b32 v[88:89], v230 offset0:0 offset1:1
    ds_read2_b32 v[90:91], v230 offset0:2 offset1:3
    ds_read_b128 v[184:187], v232 offset:512
    ds_read2_b32 v[92:93], v231 offset0:0 offset1:1
    ds_read2_b32 v[94:95], v231 offset0:2 offset1:3
    ds_read_b128 v[188:191], v232 offset:0
    s_mov_b32 s22, 0
conv_loop:
    s_waitcnt lgkmcnt(0)
    v_mfma_f32_16x16x32_bf16 v[128:131], v[64:67], v[160:163], v[128:131]
    ds_read2_b32 v[96:97], v224 offset0:16 offset1:17
    v_mfma_f32_16x16x32_bf16 v[132:135], v[68:71], v[160:163], v[132:135]
    ds_read2_b32 v[98:99], v224 offset0:18 offset1:19
    v_mfma_f32_16x16x32_bf16 v[136:139], v[72:75], v[160:163], v[136:139]
    ds_read_b128 v[192:195], v232 offset:3648
    v_mfma_f32_16x16x32_bf16 v[140:143], v[76:79], v[160:163], v[140:143]
    ds_read2_b32 v[100:101], v225 offset0:16 offset1:17
    v_mfma_f32_16x16x32_bf16 v[144:147], v[80:83], v[160:163], v[144:147]
    ds_read2_b32 v[102:103], v225 offset0:18 offset1:19
    v_mfma_f32_16x16x32_bf16 v[148:151], v[84:87], v[160:163], v[148:151]
    ds_read_b128 v[196:199], v232 offset:3136
    v_mfma_f32_16x16x32_bf16 v[152:155], v[88:91], v[160:163], v[152:155]
    ds_read2_b32 v[104:105], v226 offset0:16 offset1:17
    v_mfma_f32_16x16x32_bf16 v[156:159], v[92:95], v[160:163], v[156:159]
    ds_read2_b32 v[106:107], v226 offset0:18 offset1:19
    v_mfma_f32_16x16x32_bf16 v[132:135], v[64:67], v[164:167], v[132:135]
    ds_read_b128 v[200:203], v232 offset:2624
    v_mfma_f32_16x16x32_bf16 v[136:139], v[68:71], v[164:167], v[136:139]
    ds_read2_b32 v[108:109], v227 offset0:16 offset1:17
    v_mfma_f32_16x16x32_bf16 v[140:143], v[72:75], v[164:167], v[140:143]
    ds_read2_b32 v[110:111], v227 offset0:18 offset1:19
    v_mfma_f32_16x16x32_bf16 v[144:147], v[76:79], v[164:167], v[144:147]
    ds_read_b128 v[204:207], v232 offset:2112
    v_mfma_f32_16x16x32_bf16 v[148:151], v[80:83], v[164:167], v[148:151]
    ds_read2_b32 v[112:113], v228 offset0:16 offset1:17
    v_mfma_f32_16x16x32_bf16 v[152:155], v[84:87], v[164:167], v[152:155]
    ds_read2_b32 v[114:115], v228 offset0:18 offset1:19
    v_mfma_f32_16x16x32_bf16 v[156:159], v[88:91], v[164:167], v[156:159]
    ds_read_b128 v[208:211], v232 offset:1600
    v_mfma_f32_16x16x32_bf16 v[136:139], v[64:67], v[168:171], v[136:139]
    ds_read2_b32 v[116:117], v229 offset0:16 offset1:17
    v_mfma_f32_16x16x32_bf16 v[140:143], v[68:71], v[168:171], v[140:143]
    ds_read2_b32 v[118:119], v229 offset0:18 offset1:19
    v_mfma_f32_16x16x32_bf16 v[144:147], v[72:75], v[168:171], v[144:147]
    ds_read_b128 v[212:215], v232 offset:1088
    v_mfma_f32_16x16x32_bf16 v[148:151], v[76:79], v[168:171], v[148:151]
    ds_read2_b32 v[120:121], v230 offset0:16 offset1:17
    v_mfma_f32_16x16x32_bf16 v[152:155], v[80:83], v[168:171], v[152:155]
    ds_read2_b32 v[122:123], v230 offset0:18 offset1:19
    v_mfma_f32_16x16x32_bf16 v[156:159], v[84:87], v[168:171], v[156:159]
    ds_read_b128 v[216:219], v232 offset:576
    v_mfma_f32_16x16x32_bf16 v[140:143], v[64:67], v[172:175], v[140:143]
    ds_read2_b32 v[124:125], v231 offset0:16 offset1:17
    v_mfma_f32_16x16x32_bf16 v[144:147], v[68:71], v[172:175], v[144:147]
    ds_read2_b32 v[126:127], v231 offset0:18 offset1:19
    v_mfma_f32_16x16x32_bf16 v[148:151], v[72:75], v[172:175], v[148:151]
    ds_read_b128 v[220:223], v232 offset:64
    v_mfma_f32_16x16x32_bf16 v[152:155], v[76:79], v[172:175], v[152:155]
    v_mfma_f32_16x16x32_bf16 v[156:159], v[80:83], v[172:175], v[156:159]
    v_mfma_f32_16x16x32_bf16 v[144:147], v[64:67], v[176:179], v[144:147]
    v_mfma_f32_16x16x32_bf16 v[148:151], v[68:71], v[176:179], v[148:151]
    v_mfma_f32_16x16x32_bf16 v[152:155], v[72:75], v[176:179], v[152:155]
    v_mfma_f32_16x16x32_bf16 v[156:159], v[76:79], v[176:179], v[156:159]
    v_mfma_f32_16x16x32_bf16 v[148:151], v[64:67], v[180:183], v[148:151]
    v_mfma_f32_16x16x32_bf16 v[152:155], v[68:71], v[180:183], v[152:155]
    v_mfma_f32_16x16x32_bf16 v[156:159], v[72:75], v[180:183], v[156:159]
    v_mfma_f32_16x16x32_bf16 v[152:155], v[64:67], v[184:187], v[152:155]
    v_mfma_f32_16x16x32_bf16 v[156:159], v[68:71], v[184:187], v[156:159]
    v_mfma_f32_16x16x32_bf16 v[156:159], v[64:67], v[188:191], v[156:159]
    s_waitcnt lgkmcnt(0)
    v_mfma_f32_16x16x32_bf16 v[128:131], v[96:99], v[192:195], v[128:131]
    ds_read2_b32 v[64:65], v224 offset0:32 offset1:33
    v_mfma_f32_16x16x32_bf16 v[132:135], v[100:103], v[192:195], v[132:135]
    ds_read2_b32 v[66:67], v224 offset0:34 offset1:35
    v_mfma_f32_16x16x32_bf16 v[136:139], v[104:107], v[192:195], v[136:139]
    ds_read_b128 v[160:163], v232 offset:3712
    v_mfma_f32_16x16x32_bf16 v[140:143], v[108:111], v[192:195], v[140:143]
    ds_read2_b32 v[68:69], v225 offset0:32 offset1:33
    v_mfma_f32_16x16x32_bf16 v[144:147], v[112:115], v[192:195], v[144:147]
    ds_read2_b32 v[70:71], v225 offset0:34 offset1:35
    v_mfma_f32_16x16x32_bf16 v[148:151], v[116:119], v[192:195], v[148:151]
    ds_read_b128 v[164:167], v232 offset:3200
    v_mfma_f32_16x16x32_bf16 v[152:155], v[120:123], v[192:195], v[152:155]
    ds_read2_b32 v[72:73], v226 offset0:32 offset1:33
    v_mfma_f32_16x16x32_bf16 v[156:159], v[124:127], v[192:195], v[156:159]
    ds_read2_b32 v[74:75], v226 offset0:34 offset1:35
    v_mfma_f32_16x16x32_bf16 v[132:135], v[96:99], v[196:199], v[132:135]
    ds_read_b128 v[168:171], v232 offset:2688
    v_mfma_f32_16x16x32_bf16 v[136:139], v[100:103], v[196:199], v[136:139]
    ds_read2_b32 v[76:77], v227 offset0:32 offset1:33
    v_mfma_f32_16x16x32_bf16 v[140:143], v[104:107], v[196:199], v[140:143]
    ds_read2_b32 v[78:79], v227 offset0:34 offset1:35
    v_mfma_f32_16x16x32_bf16 v[144:147], v[108:111], v[196:199], v[144:147]
    ds_read_b128 v[172:175], v232 offset:2176
    v_mfma_f32_16x16x32_bf16 v[148:151], v[112:115], v[196:199], v[148:151]
    ds_read2_b32 v[80:81], v228 offset0:32 offset1:33
    v_mfma_f32_16x16x32_bf16 v[152:155], v[116:119], v[196:199], v[152:155]
    ds_read2_b32 v[82:83], v228 offset0:34 offset1:35
    v_mfma_f32_16x16x32_bf16 v[156:159], v[120:123], v[196:199], v[156:159]
    ds_read_b128 v[176:179], v232 offset:1664
    v_mfma_f32_16x16x32_bf16 v[136:139], v[96:99], v[200:203], v[136:139]
    ds_read2_b32 v[84:85], v229 offset0:32 offset1:33
    v_mfma_f32_16x16x32_bf16 v[140:143], v[100:103], v[200:203], v[140:143]
    ds_read2_b32 v[86:87], v229 offset0:34 offset1:35
    v_mfma_f32_16x16x32_bf16 v[144:147], v[104:107], v[200:203], v[144:147]
    ds_read_b128 v[180:183], v232 offset:1152
    v_mfma_f32_16x16x32_bf16 v[148:151], v[108:111], v[200:203], v[148:151]
    ds_read2_b32 v[88:89], v230 offset0:32 offset1:33
    v_mfma_f32_16x16x32_bf16 v[152:155], v[112:115], v[200:203], v[152:155]
    ds_read2_b32 v[90:91], v230 offset0:34 offset1:35
    v_mfma_f32_16x16x32_bf16 v[156:159], v[116:119], v[200:203], v[156:159]
    ds_read_b128 v[184:187], v232 offset:640
    v_mfma_f32_16x16x32_bf16 v[140:143], v[96:99], v[204:207], v[140:143]
    ds_read2_b32 v[92:93], v231 offset0:32 offset1:33
    v_mfma_f32_16x16x32_bf16 v[144:147], v[100:103], v[204:207], v[144:147]
    ds_read2_b32 v[94:95], v231 offset0:34 offset1:35
    v_mfma_f32_16x16x32_bf16 v[148:151], v[104:107], v[204:207], v[148:151]
    ds_read_b128 v[188:191], v232 offset:128
    v_mfma_f32_16x16x32_bf16 v[152:155], v[108:111], v[204:207], v[152:155]
    v_mfma_f32_16x16x32_bf16 v[156:159], v[112:115], v[204:207], v[156:159]
    v_mfma_f32_16x16x32_bf16 v[144:147], v[96:99], v[208:211], v[144:147]
    v_mfma_f32_16x16x32_bf16 v[148:151], v[100:103], v[208:211], v[148:151]
    v_mfma_f32_16x16x32_bf16 v[152:155], v[104:107], v[208:211], v[152:155]
    v_mfma_f32_16x16x32_bf16 v[156:159], v[108:111], v[208:211], v[156:159]
    v_mfma_f32_16x16x32_bf16 v[148:151], v[96:99], v[212:215], v[148:151]
    v_mfma_f32_16x16x32_bf16 v[152:155], v[100:103], v[212:215], v[152:155]
    v_mfma_f32_16x16x32_bf16 v[156:159], v[104:107], v[212:215], v[156:159]
    v_mfma_f32_16x16x32_bf16 v[152:155], v[96:99], v[216:219], v[152:155]
    v_mfma_f32_16x16x32_bf16 v[156:159], v[100:103], v[216:219], v[156:159]
    v_mfma_f32_16x16x32_bf16 v[156:159], v[96:99], v[220:223], v[156:159]
    v_add_u32 v224, 128, v224
    v_add_u32 v225, 128, v225
    v_add_u32 v226, 128, v226
    v_add_u32 v227, 128, v227
    v_add_u32 v228, 128, v228
    v_add_u32 v229, 128, v229
    v_add_u32 v230, 128, v230
    v_add_u32 v231, 128, v231
    v_add_u32 v232, 128, v232
    s_add_u32 s22, s22, 1
    s_cmp_lt_u32 s22, 4
    s_cbranch_scc1 conv_loop
    s_waitcnt lgkmcnt(0)
    v_lshlrev_b32 v7, 5, v5
    v_lshl_add_u32 v7, v6, 3, v7
    v_sub_u32 v7, 11896, v7
    v_add_u32 v7, v7, v2
    v_lshlrev_b32 v8, 5, v5
    v_lshl_add_u32 v8, v6, 3, v8
    s_add_u32 s21, s20, 12582912
    ds_read_b64 v[64:65], v7 offset:3584
    ds_read_b64 v[66:67], v7 offset:3072
    ds_read_b64 v[68:69], v7 offset:2560
    ds_read_b64 v[70:71], v7 offset:2048
    ds_read_b64 v[72:73], v7 offset:1536
    ds_read_b64 v[74:75], v7 offset:1024
    ds_read_b64 v[76:77], v7 offset:512
    ds_read_b64 v[78:79], v7 offset:0
    v_mov_b32 v9, s49
    s_waitcnt lgkmcnt(7)
    v_and_b32 v90, 0xffff0000, v65
    v_lshlrev_b32 v91, 16, v65
    v_and_b32 v92, 0xffff0000, v64
    v_lshlrev_b32 v93, 16, v64
    v_fmac_f32 v128, v90, v9
    v_fmac_f32 v129, v91, v9
    v_fmac_f32 v130, v92, v9
    v_fmac_f32 v131, v93, v9
    v_cvt_pk_bf16_f32 v96, v128, v129
    v_cvt_pk_bf16_f32 v97, v130, v131
    buffer_store_dwordx2 v[96:97], v8, s[16:19], s21 offen offset:0 sc1
    s_waitcnt lgkmcnt(6)
    v_and_b32 v90, 0xffff0000, v67
    v_lshlrev_b32 v91, 16, v67
    v_and_b32 v92, 0xffff0000, v66
    v_lshlrev_b32 v93, 16, v66
    v_fmac_f32 v132, v90, v9
    v_fmac_f32 v133, v91, v9
    v_fmac_f32 v134, v92, v9
    v_fmac_f32 v135, v93, v9
    v_cvt_pk_bf16_f32 v98, v132, v133
    v_cvt_pk_bf16_f32 v99, v134, v135
    buffer_store_dwordx2 v[98:99], v8, s[16:19], s21 offen offset:512 sc1
    s_waitcnt lgkmcnt(5)
    v_and_b32 v90, 0xffff0000, v69
    v_lshlrev_b32 v91, 16, v69
    v_and_b32 v92, 0xffff0000, v68
    v_lshlrev_b32 v93, 16, v68
    v_fmac_f32 v136, v90, v9
    v_fmac_f32 v137, v91, v9
    v_fmac_f32 v138, v92, v9
    v_fmac_f32 v139, v93, v9
    v_cvt_pk_bf16_f32 v100, v136, v137
    v_cvt_pk_bf16_f32 v101, v138, v139
    buffer_store_dwordx2 v[100:101], v8, s[16:19], s21 offen offset:1024 sc1
    s_waitcnt lgkmcnt(4)
    v_and_b32 v90, 0xffff0000, v71
    v_lshlrev_b32 v91, 16, v71
    v_and_b32 v92, 0xffff0000, v70
    v_lshlrev_b32 v93, 16, v70
    v_fmac_f32 v140, v90, v9
    v_fmac_f32 v141, v91, v9
    v_fmac_f32 v142, v92, v9
    v_fmac_f32 v143, v93, v9
    v_cvt_pk_bf16_f32 v102, v140, v141
    v_cvt_pk_bf16_f32 v103, v142, v143
    buffer_store_dwordx2 v[102:103], v8, s[16:19], s21 offen offset:1536 sc1
    s_waitcnt lgkmcnt(3)
    v_and_b32 v90, 0xffff0000, v73
    v_lshlrev_b32 v91, 16, v73
    v_and_b32 v92, 0xffff0000, v72
    v_lshlrev_b32 v93, 16, v72
    v_fmac_f32 v144, v90, v9
    v_fmac_f32 v145, v91, v9
    v_fmac_f32 v146, v92, v9
    v_fmac_f32 v147, v93, v9
    v_cvt_pk_bf16_f32 v104, v144, v145
    v_cvt_pk_bf16_f32 v105, v146, v147
    buffer_store_dwordx2 v[104:105], v8, s[16:19], s21 offen offset:2048 sc1
    s_waitcnt lgkmcnt(2)
    v_and_b32 v90, 0xffff0000, v75
    v_lshlrev_b32 v91, 16, v75
    v_and_b32 v92, 0xffff0000, v74
    v_lshlrev_b32 v93, 16, v74
    v_fmac_f32 v148, v90, v9
    v_fmac_f32 v149, v91, v9
    v_fmac_f32 v150, v92, v9
    v_fmac_f32 v151, v93, v9
    v_cvt_pk_bf16_f32 v106, v148, v149
    v_cvt_pk_bf16_f32 v107, v150, v151
    buffer_store_dwordx2 v[106:107], v8, s[16:19], s21 offen offset:2560 sc1
    s_waitcnt lgkmcnt(1)
    v_and_b32 v90, 0xffff0000, v77
    v_lshlrev_b32 v91, 16, v77
    v_and_b32 v92, 0xffff0000, v76
    v_lshlrev_b32 v93, 16, v76
    v_fmac_f32 v152, v90, v9
    v_fmac_f32 v153, v91, v9
    v_fmac_f32 v154, v92, v9
    v_fmac_f32 v155, v93, v9
    v_cvt_pk_bf16_f32 v108, v152, v153
    v_cvt_pk_bf16_f32 v109, v154, v155
    buffer_store_dwordx2 v[108:109], v8, s[16:19], s21 offen offset:3072 sc1
    s_waitcnt lgkmcnt(0)
    v_and_b32 v90, 0xffff0000, v79
    v_lshlrev_b32 v91, 16, v79
    v_and_b32 v92, 0xffff0000, v78
    v_lshlrev_b32 v93, 16, v78
    v_fmac_f32 v156, v90, v9
    v_fmac_f32 v157, v91, v9
    v_fmac_f32 v158, v92, v9
    v_fmac_f32 v159, v93, v9
    v_cvt_pk_bf16_f32 v110, v156, v157
    v_cvt_pk_bf16_f32 v111, v158, v159
    buffer_store_dwordx2 v[110:111], v8, s[16:19], s21 offen offset:3584 sc1
    s_waitcnt vmcnt(0)
    s_lshl_b32 s20, s46, 2
    v_mov_b32 v10, 15736832
    v_mov_b32 v11, s60
    s_mov_b64 s[62:63], exec
    s_mov_b64 exec, 1
    buffer_store_dword v11, v10, s[16:19], s20 offen sc1
    s_mov_b64 exec, s[62:63]
    s_branch k_done
aux_role:
    s_sub_u32 s30, s45, 28
    s_lshl_b32 s43, s44, 2
    s_add_u32 s43, s43, s30
    s_lshl_b32 s34, s43, 1
    s_lshr_b32 s30, s28, 2
    s_add_u32 s34, s34, s30
    s_add_u32 s34, s34, 224
    s_mul_i32 s30, s34, 205
    s_lshr_b32 s30, s30, 10
    s_mul_i32 s31, s30, 5
    s_sub_u32 s31, s34, s31
    s_mov_b32 s50, s30
    s_lshl_b32 s51, s31, 2
    s_and_b32 s30, s28, 3
    s_add_u32 s51, s51, s30
    s_lshl_b32 s55, s28, 11
    s_add_u32 s55, s55, 83968
    v_lshrrev_b32 v2, 3, v0
    v_and_b32 v3, 7, v0
    s_lshl_b32 s20, s43, 6
    v_add_u32 v4, s20, v2
    v_mul_u32_u24 v5, 1280, v4
    v_lshl_add_u32 v5, v3, 4, v5
    buffer_load_dwordx4 v[16:19], v5, s[8:11], 0 offen offset:0
    buffer_load_dwordx4 v[20:23], v5, s[8:11], 0 offen offset:128
    buffer_load_dwordx4 v[24:27], v5, s[8:11], 0 offen offset:256
    buffer_load_dwordx4 v[28:31], v5, s[8:11], 0 offen offset:384
    buffer_load_dwordx4 v[32:35], v5, s[8:11], 0 offen offset:512
    buffer_load_dwordx4 v[36:39], v5, s[8:11], 0 offen offset:640
    buffer_load_dwordx4 v[40:43], v5, s[8:11], 0 offen offset:768
    buffer_load_dwordx4 v[44:47], v5, s[8:11], 0 offen offset:896
    buffer_load_dwordx4 v[48:51], v5, s[8:11], 0 offen offset:1024
    buffer_load_dwordx4 v[52:55], v5, s[8:11], 0 offen offset:1152
    v_mov_b32 v208, 163792
    v_mov_b32 v210, 0
    v_mov_b32 v211, 0
    ds_write_b64 v208, v[210:211]
    ds_write_b64 v208, v[210:211] offset:8
    s_mov_b32 s4, s84
    s_and_b32 s5, s85, 0xffff
    s_mov_b32 s6, 2211840
    s_mov_b32 s7, 0x00020000
    v_lshrrev_b32 v200, 2, v1
    v_mul_u32_u24 v200, 1280, v200
    v_and_b32 v201, 3, v1
    v_lshl_add_u32 v200, v201, 4, v200
    s_mul_i32 s30, s50, 40960
    s_lshl_b32 s31, s51, 6
    s_add_u32 s30, s30, s31
    s_mov_b32 m0, s55
    s_add_u32 s31, s30, 20480
    buffer_load_dwordx4 v200, s[4:7], s30 offen lds
    s_add_u32 m0, s55, 1024
    s_nop 0
    buffer_load_dwordx4 v200, s[4:7], s31 offen lds
    s_mov_b32 s4, s90
    s_and_b32 s5, s91, 0xffff
    s_mov_b32 s6, 256
    s_mov_b32 s7, 0x00020000
    v_mov_b32 v205, 0
    buffer_load_dword v204, v205, s[4:7], 0 offen sc1
    v_sub_u32 v6, 63, v2
    v_mul_u32_u24 v6, 1312, v6
    v_lshl_add_u32 v6, v3, 4, v6
    s_mov_b32 s21, 52429
    s_waitcnt vmcnt(12)
    v_lshlrev_b32 v64, 16, v16
    v_and_b32 v65, 0xffff0000, v16
    v_lshlrev_b32 v66, 16, v17
    v_and_b32 v67, 0xffff0000, v17
    v_lshlrev_b32 v68, 16, v18
    v_and_b32 v69, 0xffff0000, v18
    v_lshlrev_b32 v70, 16, v19
    v_and_b32 v71, 0xffff0000, v19
    s_waitcnt vmcnt(11)
    v_lshlrev_b32 v72, 16, v20
    v_and_b32 v73, 0xffff0000, v20
    v_lshlrev_b32 v74, 16, v21
    v_and_b32 v75, 0xffff0000, v21
    v_lshlrev_b32 v76, 16, v22
    v_and_b32 v77, 0xffff0000, v22
    v_lshlrev_b32 v78, 16, v23
    v_and_b32 v79, 0xffff0000, v23
    s_waitcnt vmcnt(10)
    v_lshlrev_b32 v80, 16, v24
    v_and_b32 v81, 0xffff0000, v24
    v_lshlrev_b32 v82, 16, v25
    v_and_b32 v83, 0xffff0000, v25
    v_lshlrev_b32 v84, 16, v26
    v_and_b32 v85, 0xffff0000, v26
    v_lshlrev_b32 v86, 16, v27
    v_and_b32 v87, 0xffff0000, v27
    s_waitcnt vmcnt(9)
    v_lshlrev_b32 v88, 16, v28
    v_and_b32 v89, 0xffff0000, v28
    v_lshlrev_b32 v90, 16, v29
    v_and_b32 v91, 0xffff0000, v29
    v_lshlrev_b32 v92, 16, v30
    v_and_b32 v93, 0xffff0000, v30
    v_lshlrev_b32 v94, 16, v31
    v_and_b32 v95, 0xffff0000, v31
    s_waitcnt vmcnt(8)
    v_lshlrev_b32 v96, 16, v32
    v_and_b32 v97, 0xffff0000, v32
    v_lshlrev_b32 v98, 16, v33
    v_and_b32 v99, 0xffff0000, v33
    v_lshlrev_b32 v100, 16, v34
    v_and_b32 v101, 0xffff0000, v34
    v_lshlrev_b32 v102, 16, v35
    v_and_b32 v103, 0xffff0000, v35
    s_waitcnt vmcnt(7)
    v_lshlrev_b32 v104, 16, v36
    v_and_b32 v105, 0xffff0000, v36
    v_lshlrev_b32 v106, 16, v37
    v_and_b32 v107, 0xffff0000, v37
    v_lshlrev_b32 v108, 16, v38
    v_and_b32 v109, 0xffff0000, v38
    v_lshlrev_b32 v110, 16, v39
    v_and_b32 v111, 0xffff0000, v39
    s_waitcnt vmcnt(6)
    v_lshlrev_b32 v112, 16, v40
    v_and_b32 v113, 0xffff0000, v40
    v_lshlrev_b32 v114, 16, v41
    v_and_b32 v115, 0xffff0000, v41
    v_lshlrev_b32 v116, 16, v42
    v_and_b32 v117, 0xffff0000, v42
    v_lshlrev_b32 v118, 16, v43
    v_and_b32 v119, 0xffff0000, v43
    s_waitcnt vmcnt(5)
    v_lshlrev_b32 v120, 16, v44
    v_and_b32 v121, 0xffff0000, v44
    v_lshlrev_b32 v122, 16, v45
    v_and_b32 v123, 0xffff0000, v45
    v_lshlrev_b32 v124, 16, v46
    v_and_b32 v125, 0xffff0000, v46
    v_lshlrev_b32 v126, 16, v47
    v_and_b32 v127, 0xffff0000, v47
    s_waitcnt vmcnt(4)
    v_lshlrev_b32 v128, 16, v48
    v_and_b32 v129, 0xffff0000, v48
    v_lshlrev_b32 v130, 16, v49
    v_and_b32 v131, 0xffff0000, v49
    v_lshlrev_b32 v132, 16, v50
    v_and_b32 v133, 0xffff0000, v50
    v_lshlrev_b32 v134, 16, v51
    v_and_b32 v135, 0xffff0000, v51
    s_waitcnt vmcnt(3)
    v_lshlrev_b32 v136, 16, v52
    v_and_b32 v137, 0xffff0000, v52
    v_lshlrev_b32 v138, 16, v53
    v_and_b32 v139, 0xffff0000, v53
    v_lshlrev_b32 v140, 16, v54
    v_and_b32 v141, 0xffff0000, v54
    v_lshlrev_b32 v142, 16, v55
    v_and_b32 v143, 0xffff0000, v55
    v_pk_add_f32 v[8:9], v[64:65], v[66:67]
    v_pk_add_f32 v[10:11], v[68:69], v[70:71]
    v_pk_add_f32 v[8:9], v[8:9], v[72:73]
    v_pk_add_f32 v[10:11], v[10:11], v[74:75]
    v_pk_add_f32 v[8:9], v[8:9], v[76:77]
    v_pk_add_f32 v[10:11], v[10:11], v[78:79]
    v_pk_add_f32 v[8:9], v[8:9], v[80:81]
    v_pk_add_f32 v[10:11], v[10:11], v[82:83]
    v_pk_add_f32 v[8:9], v[8:9], v[84:85]
    v_pk_add_f32 v[10:11], v[10:11], v[86:87]
    v_pk_add_f32 v[8:9], v[8:9], v[88:89]
    v_pk_add_f32 v[10:11], v[10:11], v[90:91]
    v_pk_add_f32 v[8:9], v[8:9], v[92:93]
    v_pk_add_f32 v[10:11], v[10:11], v[94:95]
    v_pk_add_f32 v[8:9], v[8:9], v[96:97]
    v_pk_add_f32 v[10:11], v[10:11], v[98:99]
    v_pk_add_f32 v[8:9], v[8:9], v[100:101]
    v_pk_add_f32 v[10:11], v[10:11], v[102:103]
    v_pk_add_f32 v[8:9], v[8:9], v[104:105]
    v_pk_add_f32 v[10:11], v[10:11], v[106:107]
    v_pk_add_f32 v[8:9], v[8:9], v[108:109]
    v_pk_add_f32 v[10:11], v[10:11], v[110:111]
    v_pk_add_f32 v[8:9], v[8:9], v[112:113]
    v_pk_add_f32 v[10:11], v[10:11], v[114:115]
    v_pk_add_f32 v[8:9], v[8:9], v[116:117]
    v_pk_add_f32 v[10:11], v[10:11], v[118:119]
    v_pk_add_f32 v[8:9], v[8:9], v[120:121]
    v_pk_add_f32 v[10:11], v[10:11], v[122:123]
    v_pk_add_f32 v[8:9], v[8:9], v[124:125]
    v_pk_add_f32 v[10:11], v[10:11], v[126:127]
    v_pk_add_f32 v[8:9], v[8:9], v[128:129]
    v_pk_add_f32 v[10:11], v[10:11], v[130:131]
    v_pk_add_f32 v[8:9], v[8:9], v[132:133]
    v_pk_add_f32 v[10:11], v[10:11], v[134:135]
    v_pk_add_f32 v[8:9], v[8:9], v[136:137]
    v_pk_add_f32 v[10:11], v[10:11], v[138:139]
    v_pk_add_f32 v[8:9], v[8:9], v[140:141]
    v_pk_add_f32 v[10:11], v[10:11], v[142:143]
    v_pk_add_f32 v[8:9], v[8:9], v[10:11]
    v_add_f32 v8, v8, v9
    s_nop 1
    v_add_f32_dpp v8, v8, v8 quad_perm:[1,0,3,2] row_mask:0xf bank_mask:0xf
    s_nop 1
    v_add_f32_dpp v8, v8, v8 quad_perm:[2,3,0,1] row_mask:0xf bank_mask:0xf
    s_nop 1
    v_add_f32_dpp v8, v8, v8 row_half_mirror row_mask:0xf bank_mask:0xf
    v_mul_f32 v8, 0x3acccccd, v8
    v_pk_add_f32 v[64:65], v[64:65], v[8:9] op_sel_hi:[1,0] neg_lo:[0,1] neg_hi:[0,1]
    v_pk_add_f32 v[66:67], v[66:67], v[8:9] op_sel_hi:[1,0] neg_lo:[0,1] neg_hi:[0,1]
    v_pk_add_f32 v[68:69], v[68:69], v[8:9] op_sel_hi:[1,0] neg_lo:[0,1] neg_hi:[0,1]
    v_pk_add_f32 v[70:71], v[70:71], v[8:9] op_sel_hi:[1,0] neg_lo:[0,1] neg_hi:[0,1]
    v_pk_add_f32 v[72:73], v[72:73], v[8:9] op_sel_hi:[1,0] neg_lo:[0,1] neg_hi:[0,1]
    v_pk_add_f32 v[74:75], v[74:75], v[8:9] op_sel_hi:[1,0] neg_lo:[0,1] neg_hi:[0,1]
    v_pk_add_f32 v[76:77], v[76:77], v[8:9] op_sel_hi:[1,0] neg_lo:[0,1] neg_hi:[0,1]
    v_pk_add_f32 v[78:79], v[78:79], v[8:9] op_sel_hi:[1,0] neg_lo:[0,1] neg_hi:[0,1]
    v_pk_add_f32 v[80:81], v[80:81], v[8:9] op_sel_hi:[1,0] neg_lo:[0,1] neg_hi:[0,1]
    v_pk_add_f32 v[82:83], v[82:83], v[8:9] op_sel_hi:[1,0] neg_lo:[0,1] neg_hi:[0,1]
    v_pk_add_f32 v[84:85], v[84:85], v[8:9] op_sel_hi:[1,0] neg_lo:[0,1] neg_hi:[0,1]
    v_pk_add_f32 v[86:87], v[86:87], v[8:9] op_sel_hi:[1,0] neg_lo:[0,1] neg_hi:[0,1]
    v_pk_add_f32 v[88:89], v[88:89], v[8:9] op_sel_hi:[1,0] neg_lo:[0,1] neg_hi:[0,1]
    v_pk_add_f32 v[90:91], v[90:91], v[8:9] op_sel_hi:[1,0] neg_lo:[0,1] neg_hi:[0,1]
    v_pk_add_f32 v[92:93], v[92:93], v[8:9] op_sel_hi:[1,0] neg_lo:[0,1] neg_hi:[0,1]
    v_pk_add_f32 v[94:95], v[94:95], v[8:9] op_sel_hi:[1,0] neg_lo:[0,1] neg_hi:[0,1]
    v_pk_add_f32 v[96:97], v[96:97], v[8:9] op_sel_hi:[1,0] neg_lo:[0,1] neg_hi:[0,1]
    v_pk_add_f32 v[98:99], v[98:99], v[8:9] op_sel_hi:[1,0] neg_lo:[0,1] neg_hi:[0,1]
    v_pk_add_f32 v[100:101], v[100:101], v[8:9] op_sel_hi:[1,0] neg_lo:[0,1] neg_hi:[0,1]
    v_pk_add_f32 v[102:103], v[102:103], v[8:9] op_sel_hi:[1,0] neg_lo:[0,1] neg_hi:[0,1]
    v_pk_add_f32 v[104:105], v[104:105], v[8:9] op_sel_hi:[1,0] neg_lo:[0,1] neg_hi:[0,1]
    v_pk_add_f32 v[106:107], v[106:107], v[8:9] op_sel_hi:[1,0] neg_lo:[0,1] neg_hi:[0,1]
    v_pk_add_f32 v[108:109], v[108:109], v[8:9] op_sel_hi:[1,0] neg_lo:[0,1] neg_hi:[0,1]
    v_pk_add_f32 v[110:111], v[110:111], v[8:9] op_sel_hi:[1,0] neg_lo:[0,1] neg_hi:[0,1]
    v_pk_add_f32 v[112:113], v[112:113], v[8:9] op_sel_hi:[1,0] neg_lo:[0,1] neg_hi:[0,1]
    v_pk_add_f32 v[114:115], v[114:115], v[8:9] op_sel_hi:[1,0] neg_lo:[0,1] neg_hi:[0,1]
    v_pk_add_f32 v[116:117], v[116:117], v[8:9] op_sel_hi:[1,0] neg_lo:[0,1] neg_hi:[0,1]
    v_pk_add_f32 v[118:119], v[118:119], v[8:9] op_sel_hi:[1,0] neg_lo:[0,1] neg_hi:[0,1]
    v_pk_add_f32 v[120:121], v[120:121], v[8:9] op_sel_hi:[1,0] neg_lo:[0,1] neg_hi:[0,1]
    v_pk_add_f32 v[122:123], v[122:123], v[8:9] op_sel_hi:[1,0] neg_lo:[0,1] neg_hi:[0,1]
    v_pk_add_f32 v[124:125], v[124:125], v[8:9] op_sel_hi:[1,0] neg_lo:[0,1] neg_hi:[0,1]
    v_pk_add_f32 v[126:127], v[126:127], v[8:9] op_sel_hi:[1,0] neg_lo:[0,1] neg_hi:[0,1]
    v_pk_add_f32 v[128:129], v[128:129], v[8:9] op_sel_hi:[1,0] neg_lo:[0,1] neg_hi:[0,1]
    v_pk_add_f32 v[130:131], v[130:131], v[8:9] op_sel_hi:[1,0] neg_lo:[0,1] neg_hi:[0,1]
    v_pk_add_f32 v[132:133], v[132:133], v[8:9] op_sel_hi:[1,0] neg_lo:[0,1] neg_hi:[0,1]
    v_pk_add_f32 v[134:135], v[134:135], v[8:9] op_sel_hi:[1,0] neg_lo:[0,1] neg_hi:[0,1]
    v_pk_add_f32 v[136:137], v[136:137], v[8:9] op_sel_hi:[1,0] neg_lo:[0,1] neg_hi:[0,1]
    v_pk_add_f32 v[138:139], v[138:139], v[8:9] op_sel_hi:[1,0] neg_lo:[0,1] neg_hi:[0,1]
    v_pk_add_f32 v[140:141], v[140:141], v[8:9] op_sel_hi:[1,0] neg_lo:[0,1] neg_hi:[0,1]
    v_pk_add_f32 v[142:143], v[142:143], v[8:9] op_sel_hi:[1,0] neg_lo:[0,1] neg_hi:[0,1]
    v_pk_mul_f32 v[10:11], v[64:65], v[64:65]
    v_pk_mul_f32 v[12:13], v[66:67], v[66:67]
    v_pk_fma_f32 v[10:11], v[68:69], v[68:69], v[10:11]
    v_pk_fma_f32 v[12:13], v[70:71], v[70:71], v[12:13]
    v_pk_fma_f32 v[10:11], v[72:73], v[72:73], v[10:11]
    v_pk_fma_f32 v[12:13], v[74:75], v[74:75], v[12:13]
    v_pk_fma_f32 v[10:11], v[76:77], v[76:77], v[10:11]
    v_pk_fma_f32 v[12:13], v[78:79], v[78:79], v[12:13]
    v_pk_fma_f32 v[10:11], v[80:81], v[80:81], v[10:11]
    v_pk_fma_f32 v[12:13], v[82:83], v[82:83], v[12:13]
    v_pk_fma_f32 v[10:11], v[84:85], v[84:85], v[10:11]
    v_pk_fma_f32 v[12:13], v[86:87], v[86:87], v[12:13]
    v_pk_fma_f32 v[10:11], v[88:89], v[88:89], v[10:11]
    v_pk_fma_f32 v[12:13], v[90:91], v[90:91], v[12:13]
    v_pk_fma_f32 v[10:11], v[92:93], v[92:93], v[10:11]
    v_pk_fma_f32 v[12:13], v[94:95], v[94:95], v[12:13]
    v_pk_fma_f32 v[10:11], v[96:97], v[96:97], v[10:11]
    v_pk_fma_f32 v[12:13], v[98:99], v[98:99], v[12:13]
    v_pk_fma_f32 v[10:11], v[100:101], v[100:101], v[10:11]
    v_pk_fma_f32 v[12:13], v[102:103], v[102:103], v[12:13]
    v_pk_fma_f32 v[10:11], v[104:105], v[104:105], v[10:11]
    v_pk_fma_f32 v[12:13], v[106:107], v[106:107], v[12:13]
    v_pk_fma_f32 v[10:11], v[108:109], v[108:109], v[10:11]
    v_pk_fma_f32 v[12:13], v[110:111], v[110:111], v[12:13]
    v_pk_fma_f32 v[10:11], v[112:113], v[112:113], v[10:11]
    v_pk_fma_f32 v[12:13], v[114:115], v[114:115], v[12:13]
    v_pk_fma_f32 v[10:11], v[116:117], v[116:117], v[10:11]
    v_pk_fma_f32 v[12:13], v[118:119], v[118:119], v[12:13]
    v_pk_fma_f32 v[10:11], v[120:121], v[120:121], v[10:11]
    v_pk_fma_f32 v[12:13], v[122:123], v[122:123], v[12:13]
    v_pk_fma_f32 v[10:11], v[124:125], v[124:125], v[10:11]
    v_pk_fma_f32 v[12:13], v[126:127], v[126:127], v[12:13]
    v_pk_fma_f32 v[10:11], v[128:129], v[128:129], v[10:11]
    v_pk_fma_f32 v[12:13], v[130:131], v[130:131], v[12:13]
    v_pk_fma_f32 v[10:11], v[132:133], v[132:133], v[10:11]
    v_pk_fma_f32 v[12:13], v[134:135], v[134:135], v[12:13]
    v_pk_fma_f32 v[10:11], v[136:137], v[136:137], v[10:11]
    v_pk_fma_f32 v[12:13], v[138:139], v[138:139], v[12:13]
    v_pk_fma_f32 v[10:11], v[140:141], v[140:141], v[10:11]
    v_pk_fma_f32 v[12:13], v[142:143], v[142:143], v[12:13]
    v_pk_add_f32 v[10:11], v[10:11], v[12:13]
    v_add_f32 v10, v10, v11
    s_nop 1
    v_add_f32_dpp v10, v10, v10 quad_perm:[1,0,3,2] row_mask:0xf bank_mask:0xf
    s_nop 1
    v_add_f32_dpp v10, v10, v10 quad_perm:[2,3,0,1] row_mask:0xf bank_mask:0xf
    s_nop 1
    v_add_f32_dpp v10, v10, v10 row_half_mirror row_mask:0xf bank_mask:0xf
    v_mul_f32 v10, 0x3acccccd, v10
    v_cvt_pk_bf16_f32 v11, v8, v8
    v_lshlrev_b32 v11, 16, v11
    v_cvt_pk_bf16_f32 v10, v10, v10
    v_lshlrev_b32 v10, 16, v10
    v_add_f32 v10, 0x3727c5ac, v10
    v_cvt_pk_bf16_f32 v10, v10, v10
    v_lshlrev_b32 v10, 16, v10
    v_sqrt_f32 v10, v10
    s_nop 0
    v_cvt_pk_bf16_f32 v10, v10, v10
    v_lshlrev_b32 v10, 16, v10
    v_rcp_f32 v12, v10
    v_sub_f32 v14, v8, v11
    v_mul_f32 v13, v12, v11
    v_mul_f32 v14, v14, v12
    v_pk_fma_f32 v[64:65], v[64:65], v[12:13], v[14:15] op_sel_hi:[1,0,0]
    v_cvt_pk_bf16_f32 v16, v64, v65
    v_pk_fma_f32 v[66:67], v[66:67], v[12:13], v[14:15] op_sel_hi:[1,0,0]
    v_cvt_pk_bf16_f32 v17, v66, v67
    v_pk_fma_f32 v[68:69], v[68:69], v[12:13], v[14:15] op_sel_hi:[1,0,0]
    v_cvt_pk_bf16_f32 v18, v68, v69
    v_pk_fma_f32 v[70:71], v[70:71], v[12:13], v[14:15] op_sel_hi:[1,0,0]
    v_cvt_pk_bf16_f32 v19, v70, v71
    v_pk_fma_f32 v[72:73], v[72:73], v[12:13], v[14:15] op_sel_hi:[1,0,0]
    v_cvt_pk_bf16_f32 v20, v72, v73
    v_pk_fma_f32 v[74:75], v[74:75], v[12:13], v[14:15] op_sel_hi:[1,0,0]
    v_cvt_pk_bf16_f32 v21, v74, v75
    v_pk_fma_f32 v[76:77], v[76:77], v[12:13], v[14:15] op_sel_hi:[1,0,0]
    v_cvt_pk_bf16_f32 v22, v76, v77
    v_pk_fma_f32 v[78:79], v[78:79], v[12:13], v[14:15] op_sel_hi:[1,0,0]
    v_cvt_pk_bf16_f32 v23, v78, v79
    v_pk_fma_f32 v[80:81], v[80:81], v[12:13], v[14:15] op_sel_hi:[1,0,0]
    v_cvt_pk_bf16_f32 v24, v80, v81
    v_pk_fma_f32 v[82:83], v[82:83], v[12:13], v[14:15] op_sel_hi:[1,0,0]
    v_cvt_pk_bf16_f32 v25, v82, v83
    v_pk_fma_f32 v[84:85], v[84:85], v[12:13], v[14:15] op_sel_hi:[1,0,0]
    v_cvt_pk_bf16_f32 v26, v84, v85
    v_pk_fma_f32 v[86:87], v[86:87], v[12:13], v[14:15] op_sel_hi:[1,0,0]
    v_cvt_pk_bf16_f32 v27, v86, v87
    v_pk_fma_f32 v[88:89], v[88:89], v[12:13], v[14:15] op_sel_hi:[1,0,0]
    v_cvt_pk_bf16_f32 v28, v88, v89
    v_pk_fma_f32 v[90:91], v[90:91], v[12:13], v[14:15] op_sel_hi:[1,0,0]
    v_cvt_pk_bf16_f32 v29, v90, v91
    v_pk_fma_f32 v[92:93], v[92:93], v[12:13], v[14:15] op_sel_hi:[1,0,0]
    v_cvt_pk_bf16_f32 v30, v92, v93
    v_pk_fma_f32 v[94:95], v[94:95], v[12:13], v[14:15] op_sel_hi:[1,0,0]
    v_cvt_pk_bf16_f32 v31, v94, v95
    v_pk_fma_f32 v[96:97], v[96:97], v[12:13], v[14:15] op_sel_hi:[1,0,0]
    v_cvt_pk_bf16_f32 v32, v96, v97
    v_pk_fma_f32 v[98:99], v[98:99], v[12:13], v[14:15] op_sel_hi:[1,0,0]
    v_cvt_pk_bf16_f32 v33, v98, v99
    v_pk_fma_f32 v[100:101], v[100:101], v[12:13], v[14:15] op_sel_hi:[1,0,0]
    v_cvt_pk_bf16_f32 v34, v100, v101
    v_pk_fma_f32 v[102:103], v[102:103], v[12:13], v[14:15] op_sel_hi:[1,0,0]
    v_cvt_pk_bf16_f32 v35, v102, v103
    v_pk_fma_f32 v[104:105], v[104:105], v[12:13], v[14:15] op_sel_hi:[1,0,0]
    v_cvt_pk_bf16_f32 v36, v104, v105
    v_pk_fma_f32 v[106:107], v[106:107], v[12:13], v[14:15] op_sel_hi:[1,0,0]
    v_cvt_pk_bf16_f32 v37, v106, v107
    v_pk_fma_f32 v[108:109], v[108:109], v[12:13], v[14:15] op_sel_hi:[1,0,0]
    v_cvt_pk_bf16_f32 v38, v108, v109
    v_pk_fma_f32 v[110:111], v[110:111], v[12:13], v[14:15] op_sel_hi:[1,0,0]
    v_cvt_pk_bf16_f32 v39, v110, v111
    v_pk_fma_f32 v[112:113], v[112:113], v[12:13], v[14:15] op_sel_hi:[1,0,0]
    v_cvt_pk_bf16_f32 v40, v112, v113
    v_pk_fma_f32 v[114:115], v[114:115], v[12:13], v[14:15] op_sel_hi:[1,0,0]
    v_cvt_pk_bf16_f32 v41, v114, v115
    v_pk_fma_f32 v[116:117], v[116:117], v[12:13], v[14:15] op_sel_hi:[1,0,0]
    v_cvt_pk_bf16_f32 v42, v116, v117
    v_pk_fma_f32 v[118:119], v[118:119], v[12:13], v[14:15] op_sel_hi:[1,0,0]
    v_cvt_pk_bf16_f32 v43, v118, v119
    v_pk_fma_f32 v[120:121], v[120:121], v[12:13], v[14:15] op_sel_hi:[1,0,0]
    v_cvt_pk_bf16_f32 v44, v120, v121
    v_pk_fma_f32 v[122:123], v[122:123], v[12:13], v[14:15] op_sel_hi:[1,0,0]
    v_cvt_pk_bf16_f32 v45, v122, v123
    v_pk_fma_f32 v[124:125], v[124:125], v[12:13], v[14:15] op_sel_hi:[1,0,0]
    v_cvt_pk_bf16_f32 v46, v124, v125
    v_pk_fma_f32 v[126:127], v[126:127], v[12:13], v[14:15] op_sel_hi:[1,0,0]
    v_cvt_pk_bf16_f32 v47, v126, v127
    v_pk_fma_f32 v[128:129], v[128:129], v[12:13], v[14:15] op_sel_hi:[1,0,0]
    v_cvt_pk_bf16_f32 v48, v128, v129
    v_pk_fma_f32 v[130:131], v[130:131], v[12:13], v[14:15] op_sel_hi:[1,0,0]
    v_cvt_pk_bf16_f32 v49, v130, v131
    v_pk_fma_f32 v[132:133], v[132:133], v[12:13], v[14:15] op_sel_hi:[1,0,0]
    v_cvt_pk_bf16_f32 v50, v132, v133
    v_pk_fma_f32 v[134:135], v[134:135], v[12:13], v[14:15] op_sel_hi:[1,0,0]
    v_cvt_pk_bf16_f32 v51, v134, v135
    v_pk_fma_f32 v[136:137], v[136:137], v[12:13], v[14:15] op_sel_hi:[1,0,0]
    v_cvt_pk_bf16_f32 v52, v136, v137
    v_pk_fma_f32 v[138:139], v[138:139], v[12:13], v[14:15] op_sel_hi:[1,0,0]
    v_cvt_pk_bf16_f32 v53, v138, v139
    v_pk_fma_f32 v[140:141], v[140:141], v[12:13], v[14:15] op_sel_hi:[1,0,0]
    v_cvt_pk_bf16_f32 v54, v140, v141
    v_pk_fma_f32 v[142:143], v[142:143], v[12:13], v[14:15] op_sel_hi:[1,0,0]
    v_cvt_pk_bf16_f32 v55, v142, v143
    s_waitcnt vmcnt(0)
    v_readfirstlane_b32 s60, v204
    s_nop 3
    s_cmp_lg_u32 s60, 0
    s_cbranch_scc1 nonce_ok9
    s_mov_b32 s4, s90
    s_and_b32 s5, s91, 0xffff
    s_mov_b32 s6, 256
    s_mov_b32 s7, 0x00020000
    s_mov_b32 s61, 0
    v_mov_b32 v205, 0
nonce_spin9:
    buffer_load_dword v204, v205, s[4:7], 0 offen sc1
    s_waitcnt vmcnt(0)
    v_readfirstlane_b32 s60, v204
    s_nop 3
    s_cmp_lg_u32 s60, 0
    s_cbranch_scc1 nonce_ok9
    s_sleep 1
    s_add_u32 s61, s61, 1
    s_cmp_lt_u32 s61, 0x8000
    s_cbranch_scc1 nonce_spin9
nonce_ok9:
    v_lshlrev_b32 v15, 4, v4
    v_add_u32 v15, 2752512, v15
    v_mov_b32 v60, v12
    v_mov_b32 v61, v13
    v_mov_b32 v62, s60
    v_mov_b32 v63, 0
    v_cmp_eq_u32 vcc, 0, v3
    s_nop 3
    s_and_saveexec_b64 s[22:23], vcc
    buffer_store_dwordx4 v[60:63], v15, s[16:19], 0 offen sc1
    s_mov_b64 exec, s[22:23]
    ds_write_b128 v6, v[16:19] offset:0
    ds_write_b128 v6, v[20:23] offset:128
    ds_write_b128 v6, v[24:27] offset:256
    ds_write_b128 v6, v[28:31] offset:384
    ds_write_b128 v6, v[32:35] offset:512
    ds_write_b128 v6, v[36:39] offset:640
    ds_write_b128 v6, v[40:43] offset:768
    ds_write_b128 v6, v[44:47] offset:896
    ds_write_b128 v6, v[48:51] offset:1024
    ds_write_b128 v6, v[52:55] offset:1152
    v_lshrrev_b32 v3, 4, v1
    v_bfe_u32 v4, v1, 2, 2
    v_and_b32 v5, 3, v1
    v_lshl_add_u32 v4, v3, 3, v4
    v_mul_u32_u24 v4, 1312, v4
    v_lshl_add_u32 v4, v5, 3, v4
    s_lshl_b32 s22, s28, 5
    v_add_u32 v4, s22, v4
    v_and_b32 v5, 7, v1
    s_lshl_b32 s22, s28, 4
    v_add_u32 v5, s22, v5
    v_mul_u32_u24 v5, 4224, v5
    v_bfe_u32 v6, v1, 3, 1
    v_lshl_add_u32 v6, v6, 2, v3
    v_lshl_add_u32 v5, v6, 4, v5
    s_lshl_b32 s22, s43, 7
    s_sub_u32 s22, 3968, s22
    v_add_u32 v5, s22, v5
    v_add_u32 v7, 33792, v5
    s_waitcnt lgkmcnt(0)
    s_barrier
    s_cmp_ge_u32 s50, 54
    s_cbranch_scc1 aux_now2
    v_lshrrev_b32 v176, 2, v1
    v_lshlrev_b32 v176, 6, v176
    v_and_b32 v177, 3, v1
    v_lshl_add_u32 v176, v177, 3, v176
    v_add_u32 v176, s55, v176
    ds_read_b64_tr_b16 v[180:181], v176
    ds_read_b64_tr_b16 v[182:183], v176 offset:1024
    ds_read_b64_tr_b16 v[184:185], v176 offset:32
    ds_read_b64_tr_b16 v[186:187], v176 offset:1056
    s_mul_i32 s30, s51, 108
    s_add_u32 s30, s30, s50
    s_lshl_b32 s30, s30, 10
    s_add_u32 s30, s30, 2818048
    v_lshlrev_b32 v177, 4, v1
    s_add_u32 s31, s30, 55296
    s_waitcnt lgkmcnt(0)
    buffer_store_dwordx4 v[180:183], v177, s[16:19], s30 offen sc1
    buffer_store_dwordx4 v[184:187], v177, s[16:19], s31 offen sc1
    s_waitcnt vmcnt(0)
    s_mul_i32 s30, s50, 80
    s_lshl_b32 s31, s51, 2
    s_add_u32 s30, s30, s31
    v_mov_b32 v176, 15745024
    v_mov_b32 v177, s60
    s_mov_b64 s[62:63], exec
    s_mov_b64 exec, 1
    buffer_store_dword v177, v176, s[16:19], s30 offen sc1
    s_mov_b64 exec, s[62:63]
aux_now2:
    ds_read_b64_tr_b16 v[16:17], v4 offset:0
    ds_read_b64_tr_b16 v[18:19], v4 offset:5248
    ds_read_b64_tr_b16 v[20:21], v4 offset:41984
    ds_read_b64_tr_b16 v[22:23], v4 offset:47232
    ds_read_b64_tr_b16 v[24:25], v4 offset:256
    ds_read_b64_tr_b16 v[26:27], v4 offset:5504
    ds_read_b64_tr_b16 v[28:29], v4 offset:42240
    ds_read_b64_tr_b16 v[30:31], v4 offset:47488
    ds_read_b64_tr_b16 v[32:33], v4 offset:512
    ds_read_b64_tr_b16 v[34:35], v4 offset:5760
    ds_read_b64_tr_b16 v[36:37], v4 offset:42496
    ds_read_b64_tr_b16 v[38:39], v4 offset:47744
    ds_read_b64_tr_b16 v[40:41], v4 offset:768
    ds_read_b64_tr_b16 v[42:43], v4 offset:6016
    ds_read_b64_tr_b16 v[44:45], v4 offset:42752
    ds_read_b64_tr_b16 v[46:47], v4 offset:48000
    ds_read_b64_tr_b16 v[48:49], v4 offset:1024
    ds_read_b64_tr_b16 v[50:51], v4 offset:6272
    ds_read_b64_tr_b16 v[52:53], v4 offset:43008
    ds_read_b64_tr_b16 v[54:55], v4 offset:48256
    s_waitcnt lgkmcnt(15)
    v_mov_b32 v64, v16
    v_mov_b32 v68, v20
    v_mov_b32 v65, v17
    v_mov_b32 v69, v21
    v_mov_b32 v66, v18
    v_mov_b32 v70, v22
    v_mov_b32 v67, v19
    v_mov_b32 v71, v23
    v_mov_b32_dpp v64, v20 row_shr:8 row_mask:0xf bank_mask:0xc
    v_mov_b32_dpp v68, v16 row_shl:8 row_mask:0xf bank_mask:0x3
    v_mov_b32_dpp v65, v21 row_shr:8 row_mask:0xf bank_mask:0xc
    v_mov_b32_dpp v69, v17 row_shl:8 row_mask:0xf bank_mask:0x3
    v_mov_b32_dpp v66, v22 row_shr:8 row_mask:0xf bank_mask:0xc
    v_mov_b32_dpp v70, v18 row_shl:8 row_mask:0xf bank_mask:0x3
    v_mov_b32_dpp v67, v23 row_shr:8 row_mask:0xf bank_mask:0xc
    v_mov_b32_dpp v71, v19 row_shl:8 row_mask:0xf bank_mask:0x3
    s_mov_b32 s20, 0
    buffer_store_dwordx4 v[64:67], v5, s[16:19], s20 offen sc1
    buffer_store_dwordx4 v[68:71], v7, s[16:19], s20 offen sc1
    s_waitcnt lgkmcnt(12)
    v_mov_b32 v72, v24
    v_mov_b32 v76, v28
    v_mov_b32 v73, v25
    v_mov_b32 v77, v29
    v_mov_b32 v74, v26
    v_mov_b32 v78, v30
    v_mov_b32 v75, v27
    v_mov_b32 v79, v31
    v_mov_b32_dpp v72, v28 row_shr:8 row_mask:0xf bank_mask:0xc
    v_mov_b32_dpp v76, v24 row_shl:8 row_mask:0xf bank_mask:0x3
    v_mov_b32_dpp v73, v29 row_shr:8 row_mask:0xf bank_mask:0xc
    v_mov_b32_dpp v77, v25 row_shl:8 row_mask:0xf bank_mask:0x3
    v_mov_b32_dpp v74, v30 row_shr:8 row_mask:0xf bank_mask:0xc
    v_mov_b32_dpp v78, v26 row_shl:8 row_mask:0xf bank_mask:0x3
    v_mov_b32_dpp v75, v31 row_shr:8 row_mask:0xf bank_mask:0xc
    v_mov_b32_dpp v79, v27 row_shl:8 row_mask:0xf bank_mask:0x3
    s_mov_b32 s20, 540672
    buffer_store_dwordx4 v[72:75], v5, s[16:19], s20 offen sc1
    buffer_store_dwordx4 v[76:79], v7, s[16:19], s20 offen sc1
    s_waitcnt lgkmcnt(8)
    v_mov_b32 v80, v32
    v_mov_b32 v84, v36
    v_mov_b32 v81, v33
    v_mov_b32 v85, v37
    v_mov_b32 v82, v34
    v_mov_b32 v86, v38
    v_mov_b32 v83, v35
    v_mov_b32 v87, v39
    v_mov_b32_dpp v80, v36 row_shr:8 row_mask:0xf bank_mask:0xc
    v_mov_b32_dpp v84, v32 row_shl:8 row_mask:0xf bank_mask:0x3
    v_mov_b32_dpp v81, v37 row_shr:8 row_mask:0xf bank_mask:0xc
    v_mov_b32_dpp v85, v33 row_shl:8 row_mask:0xf bank_mask:0x3
    v_mov_b32_dpp v82, v38 row_shr:8 row_mask:0xf bank_mask:0xc
    v_mov_b32_dpp v86, v34 row_shl:8 row_mask:0xf bank_mask:0x3
    v_mov_b32_dpp v83, v39 row_shr:8 row_mask:0xf bank_mask:0xc
    v_mov_b32_dpp v87, v35 row_shl:8 row_mask:0xf bank_mask:0x3
    s_mov_b32 s20, 1081344
    buffer_store_dwordx4 v[80:83], v5, s[16:19], s20 offen sc1
    buffer_store_dwordx4 v[84:87], v7, s[16:19], s20 offen sc1
    s_waitcnt lgkmcnt(4)
    v_mov_b32 v88, v40
    v_mov_b32 v92, v44
    v_mov_b32 v89, v41
    v_mov_b32 v93, v45
    v_mov_b32 v90, v42
    v_mov_b32 v94, v46
    v_mov_b32 v91, v43
    v_mov_b32 v95, v47
    v_mov_b32_dpp v88, v44 row_shr:8 row_mask:0xf bank_mask:0xc
    v_mov_b32_dpp v92, v40 row_shl:8 row_mask:0xf bank_mask:0x3
    v_mov_b32_dpp v89, v45 row_shr:8 row_mask:0xf bank_mask:0xc
    v_mov_b32_dpp v93, v41 row_shl:8 row_mask:0xf bank_mask:0x3
    v_mov_b32_dpp v90, v46 row_shr:8 row_mask:0xf bank_mask:0xc
    v_mov_b32_dpp v94, v42 row_shl:8 row_mask:0xf bank_mask:0x3
    v_mov_b32_dpp v91, v47 row_shr:8 row_mask:0xf bank_mask:0xc
    v_mov_b32_dpp v95, v43 row_shl:8 row_mask:0xf bank_mask:0x3
    s_mov_b32 s20, 1622016
    buffer_store_dwordx4 v[88:91], v5, s[16:19], s20 offen sc1
    buffer_store_dwordx4 v[92:95], v7, s[16:19], s20 offen sc1
    s_waitcnt lgkmcnt(0)
    v_mov_b32 v96, v48
    v_mov_b32 v100, v52
    v_mov_b32 v97, v49
    v_mov_b32 v101, v53
    v_mov_b32 v98, v50
    v_mov_b32 v102, v54
    v_mov_b32 v99, v51
    v_mov_b32 v103, v55
    v_mov_b32_dpp v96, v52 row_shr:8 row_mask:0xf bank_mask:0xc
    v_mov_b32_dpp v100, v48 row_shl:8 row_mask:0xf bank_mask:0x3
    v_mov_b32_dpp v97, v53 row_shr:8 row_mask:0xf bank_mask:0xc
    v_mov_b32_dpp v101, v49 row_shl:8 row_mask:0xf bank_mask:0x3
    v_mov_b32_dpp v98, v54 row_shr:8 row_mask:0xf bank_mask:0xc
    v_mov_b32_dpp v102, v50 row_shl:8 row_mask:0xf bank_mask:0x3
    v_mov_b32_dpp v99, v55 row_shr:8 row_mask:0xf bank_mask:0xc
    v_mov_b32_dpp v103, v51 row_shl:8 row_mask:0xf bank_mask:0x3
    s_mov_b32 s20, 2162688
    buffer_store_dwordx4 v[96:99], v5, s[16:19], s20 offen sc1
    buffer_store_dwordx4 v[100:103], v7, s[16:19], s20 offen sc1
    s_waitcnt vmcnt(0)
    s_barrier
    s_cmp_lg_u32 s28, 0
    s_cbranch_scc1 lnskip10
    s_lshl_b32 s30, s43, 2
    v_mov_b32 v100, 15728640
    v_mov_b32 v101, s60
    s_mov_b64 s[62:63], exec
    s_mov_b64 exec, 1
    buffer_store_dword v101, v100, s[16:19], s30 offen sc1
    s_mov_b64 exec, s[62:63]
lnskip10:
aux_now2b:
    s_mov_b32 s27, 0
    s_cmp_lt_u32 s28, 4
    s_cbranch_scc1 gemm2_path
    s_cmp_lg_u32 s28, 7
    s_cbranch_scc1 k_done
poll_role:
    s_lshl_b32 s40, s44, 2
    s_lshr_b32 s30, s45, 3
    s_add_u32 s40, s40, s30
    s_and_b32 s41, s45, 7
    s_mul_i32 s31, s41, 5
    s_lshr_b32 s31, s31, 1
    s_lshl_b32 s31, s31, 2
    s_add_u32 s31, s31, 15745024
    v_mul_u32_u24 v98, 80, v1
    v_add_u32 v98, s31, v98
    v_cmp_gt_u32 vcc, 54, v1
    s_nop 3
    s_and_saveexec_b64 s[62:63], vcc
    s_mov_b32 s61, 0
pl_spin11:
    buffer_load_dwordx3 v[100:102], v98, s[16:19], 0 offen sc1
    s_waitcnt vmcnt(0)
    v_cmp_ne_u32 vcc, s60, v100
    v_cmp_ne_u32 s[58:59], s60, v101
    s_nop 3
    s_or_b64 vcc, vcc, s[58:59]
    v_cmp_ne_u32 s[58:59], s60, v102
    s_nop 3
    s_or_b64 vcc, vcc, s[58:59]
    s_cbranch_vccz pl_ok11
    s_sleep 10
    s_add_u32 s61, s61, 1
    s_cmp_lt_u32 s61, 0x8000
    s_cbranch_scc1 pl_spin11
pl_ok11:
    s_mov_b64 exec, s[62:63]
    v_mov_b32 v96, 163792
    v_mov_b32 v97, 1
    ds_write_b32 v96, v97
    s_lshr_b32 s30, s40, 1
    s_lshl_b32 s30, s30, 8
    v_lshlrev_b32 v96, 2, v1
    v_add_u32 v96, 15729152, v96
    v_add_u32 v96, s30, v96
    v_cmp_gt_u32 vcc, 56, v1
    s_nop 3
    s_and_saveexec_b64 s[62:63], vcc
    s_mov_b32 s61, 0
pl_spin12:
    buffer_load_dword v98, v96, s[16:19], 0 offen sc1
    s_waitcnt vmcnt(0)
    v_cmp_ne_u32 vcc, s60, v98
    s_nop 3
    s_cbranch_vccz pl_ok12
    s_sleep 10
    s_add_u32 s61, s61, 1
    s_cmp_lt_u32 s61, 0x8000
    s_cbranch_scc1 pl_spin12
pl_ok12:
    s_mov_b64 exec, s[62:63]
    v_mov_b32 v96, 163796
    v_mov_b32 v97, 1
    ds_write_b32 v96, v97
    v_mov_b32 v96, 163804
lw13:
    ds_read_b32 v97, v96
    s_waitcnt lgkmcnt(0)
    v_readfirstlane_b32 s30, v97
    s_nop 3
    s_cmp_eq_u32 s30, 1
    s_cbranch_scc1 lw_ok13
    s_sleep 8
    s_branch lw13
lw_ok13:
    s_mul_i32 s30, s41, 320
    v_lshlrev_b32 v96, 3, v1
    v_add_u32 v96, 15736832, v96
    v_add_u32 v96, s30, v96
    v_cmp_gt_u32 vcc, 40, v1
    s_nop 3
    s_and_saveexec_b64 s[62:63], vcc
    s_mov_b32 s61, 0
pl_spin14:
    buffer_load_dwordx2 v[98:99], v96, s[16:19], 0 offen sc1
    s_waitcnt vmcnt(0)
    v_cmp_ne_u32 vcc, s60, v98
    v_cmp_ne_u32 s[58:59], s60, v99
    s_nop 3
    s_or_b64 vcc, vcc, s[58:59]
    s_cbranch_vccz pl_ok14
    s_sleep 10
    s_add_u32 s61, s61, 1
    s_cmp_lt_u32 s61, 0x8000
    s_cbranch_scc1 pl_spin14
pl_ok14:
    s_mov_b64 exec, s[62:63]
    v_mov_b32 v96, 163800
    v_mov_b32 v97, 1
    ds_write_b32 v96, v97
    s_waitcnt lgkmcnt(0)
    s_branch k_done
gemm2_path:
    s_setprio 1
    s_mov_b32 s56, s42
    s_mov_b32 s57, s41
    s_lshl_b32 s40, s44, 2
    s_lshr_b32 s30, s45, 3
    s_add_u32 s40, s40, s30
    s_and_b32 s41, s45, 7
    s_mov_b32 s12, s86
    s_and_b32 s13, s87, 0xffff
    s_mov_b32 s14, 1280
    s_mov_b32 s15, 0x00020000
    s_mov_b32 s20, s88
    s_and_b32 s21, s89, 0xffff
    s_mov_b32 s22, 2621440
    s_mov_b32 s23, 0x00020000
    s_cmp_eq_u32 s27, 0
    s_cbranch_scc1 noh15
    s_waitcnt vmcnt(0)
    s_lshl_b32 s30, s56, 8
    s_lshl_b32 s31, s57, 4
    s_add_u32 s30, s30, s31
    s_lshl_b32 s31, s28, 2
    s_add_u32 s30, s30, s31
    v_mov_b32 v96, 15729152
    v_mov_b32 v97, s60
    s_mov_b64 s[62:63], exec
    s_mov_b64 exec, 1
    buffer_store_dword v97, v96, s[16:19], s30 offen sc1
    s_mov_b64 exec, s[62:63]
noh15:
    v_lshlrev_b32 v104, 4, v1
    v_add_u32 v105, 55296, v104
    v_add_u32 v106, 110592, v104
    v_add_u32 v107, 165888, v104
    v_add_u32 v108, 221184, v104
    s_mul_i32 s30, s28, 14
    s_mul_i32 s31, s41, 270
    s_add_u32 s31, s31, s30
    s_lshl_b32 s31, s31, 10
    s_add_u32 s52, s31, 2818048
    s_mul_i32 s31, s40, 216
    s_add_u32 s31, s31, s30
    s_lshl_b32 s31, s31, 10
    s_add_u32 s53, s31, 5242880
    s_cmp_eq_u32 s28, 3
    s_cselect_b32 s54, 12, 14
    s_mul_i32 s33, s41, 0
    s_lshr_b32 s33, s33, 2
    s_and_b32 s30, s40, 3
    s_mul_i32 s30, s30, 0
    s_lshr_b32 s30, s30, 1
    s_add_u32 s33, s33, s30
    s_cmp_ge_u32 s33, 14
    s_cselect_b32 s30, 14, 0
    s_sub_u32 s33, s33, s30
    s_cmp_ge_u32 s33, 14
    s_cselect_b32 s30, 14, 0
    s_sub_u32 s33, s33, s30
    s_mov_b32 s34, s33
    v_mov_b32 v96, 163792
lw16:
    ds_read_b32 v97, v96
    s_waitcnt lgkmcnt(0)
    v_readfirstlane_b32 s30, v97
    s_nop 3
    s_cmp_eq_u32 s30, 1
    s_cbranch_scc1 lw_ok16
    s_sleep 1
    s_branch lw16
lw_ok16:
    s_lshl_b32 s30, s33, 10
    s_add_u32 s30, s30, s52
    s_cmp_ge_u32 s33, s54
    s_cselect_b32 s31, 0x40000000, 0
    s_add_u32 s30, s30, s31
    s_add_u32 s33, s33, 1
    s_cmp_eq_u32 s33, 14
    s_cselect_b32 s33, 0, s33
    buffer_load_dwordx4 v[112:115], v104, s[16:19], s30 offen sc1
    buffer_load_dwordx4 v[116:119], v105, s[16:19], s30 offen sc1
    buffer_load_dwordx4 v[120:123], v106, s[16:19], s30 offen sc1
    buffer_load_dwordx4 v[124:127], v107, s[16:19], s30 offen sc1
    buffer_load_dwordx4 v[128:131], v108, s[16:19], s30 offen sc1
    s_lshl_b32 s30, s33, 10
    s_add_u32 s30, s30, s52
    s_cmp_ge_u32 s33, s54
    s_cselect_b32 s31, 0x40000000, 0
    s_add_u32 s30, s30, s31
    s_add_u32 s33, s33, 1
    s_cmp_eq_u32 s33, 14
    s_cselect_b32 s33, 0, s33
    buffer_load_dwordx4 v[148:151], v104, s[16:19], s30 offen sc1
    buffer_load_dwordx4 v[152:155], v105, s[16:19], s30 offen sc1
    buffer_load_dwordx4 v[156:159], v106, s[16:19], s30 offen sc1
    buffer_load_dwordx4 v[160:163], v107, s[16:19], s30 offen sc1
    buffer_load_dwordx4 v[164:167], v108, s[16:19], s30 offen sc1
    s_lshl_b32 s30, s33, 10
    s_add_u32 s30, s30, s52
    s_cmp_ge_u32 s33, s54
    s_cselect_b32 s31, 0x40000000, 0
    s_add_u32 s30, s30, s31
    s_add_u32 s33, s33, 1
    s_cmp_eq_u32 s33, 14
    s_cselect_b32 s33, 0, s33
    buffer_load_dwordx4 v[184:187], v104, s[16:19], s30 offen sc1
    buffer_load_dwordx4 v[188:191], v105, s[16:19], s30 offen sc1
    buffer_load_dwordx4 v[192:195], v106, s[16:19], s30 offen sc1
    buffer_load_dwordx4 v[196:199], v107, s[16:19], s30 offen sc1
    buffer_load_dwordx4 v[200:203], v108, s[16:19], s30 offen sc1
    s_lshl_b32 s30, s33, 10
    s_add_u32 s30, s30, s52
    s_cmp_ge_u32 s33, s54
    s_cselect_b32 s31, 0x40000000, 0
    s_add_u32 s30, s30, s31
    s_add_u32 s33, s33, 1
    s_cmp_eq_u32 s33, 14
    s_cselect_b32 s33, 0, s33
    buffer_load_dwordx4 v[220:223], v104, s[16:19], s30 offen sc1
    buffer_load_dwordx4 v[224:227], v105, s[16:19], s30 offen sc1
    buffer_load_dwordx4 v[228:231], v106, s[16:19], s30 offen sc1
    buffer_load_dwordx4 v[232:235], v107, s[16:19], s30 offen sc1
    buffer_load_dwordx4 v[236:239], v108, s[16:19], s30 offen sc1
    s_add_u32 s30, s28, 0
    s_and_b32 s30, s30, 3
    s_mul_i32 s30, s30, 55296
    v_add_u32 v7, s30, v104
    s_add_u32 s30, s28, 1
    s_and_b32 s30, s30, 3
    s_mul_i32 s30, s30, 55296
    v_add_u32 v8, s30, v104
    s_add_u32 s30, s28, 2
    s_and_b32 s30, s30, 3
    s_mul_i32 s30, s30, 55296
    v_add_u32 v9, s30, v104
    s_add_u32 s30, s28, 3
    s_and_b32 s30, s30, 3
    s_mul_i32 s30, s30, 55296
    v_add_u32 v10, s30, v104
    v_mov_b32 v96, 163796
lw17:
    ds_read_b32 v97, v96
    s_waitcnt lgkmcnt(0)
    v_readfirstlane_b32 s30, v97
    s_nop 3
    s_cmp_eq_u32 s30, 1
    s_cbranch_scc1 lw_ok17
    s_sleep 1
    s_branch lw17
lw_ok17:
    s_lshl_b32 s30, s34, 10
    s_add_u32 s30, s30, s53
    s_cmp_ge_u32 s34, s54
    s_cselect_b32 s31, 0x40000000, 0
    s_add_u32 s30, s30, s31
    s_add_u32 s34, s34, 1
    s_cmp_eq_u32 s34, 14
    s_cselect_b32 s34, 0, s34
    buffer_load_dwordx4 v[132:135], v7, s[16:19], s30 offen sc1
    buffer_load_dwordx4 v[136:139], v8, s[16:19], s30 offen sc1
    buffer_load_dwordx4 v[140:143], v9, s[16:19], s30 offen sc1
    buffer_load_dwordx4 v[144:147], v10, s[16:19], s30 offen sc1
    s_lshl_b32 s30, s34, 10
    s_add_u32 s30, s30, s53
    s_cmp_ge_u32 s34, s54
    s_cselect_b32 s31, 0x40000000, 0
    s_add_u32 s30, s30, s31
    s_add_u32 s34, s34, 1
    s_cmp_eq_u32 s34, 14
    s_cselect_b32 s34, 0, s34
    buffer_load_dwordx4 v[168:171], v7, s[16:19], s30 offen sc1
    buffer_load_dwordx4 v[172:175], v8, s[16:19], s30 offen sc1
    buffer_load_dwordx4 v[176:179], v9, s[16:19], s30 offen sc1
    buffer_load_dwordx4 v[180:183], v10, s[16:19], s30 offen sc1
    s_lshl_b32 s30, s34, 10
    s_add_u32 s30, s30, s53
    s_cmp_ge_u32 s34, s54
    s_cselect_b32 s31, 0x40000000, 0
    s_add_u32 s30, s30, s31
    s_add_u32 s34, s34, 1
    s_cmp_eq_u32 s34, 14
    s_cselect_b32 s34, 0, s34
    buffer_load_dwordx4 v[204:207], v7, s[16:19], s30 offen sc1
    buffer_load_dwordx4 v[208:211], v8, s[16:19], s30 offen sc1
    buffer_load_dwordx4 v[212:215], v9, s[16:19], s30 offen sc1
    buffer_load_dwordx4 v[216:219], v10, s[16:19], s30 offen sc1
    v_mov_b32 v16, 0
    v_mov_b32 v17, 0
    v_mov_b32 v18, 0
    v_mov_b32 v19, 0
    v_mov_b32 v20, 0
    v_mov_b32 v21, 0
    v_mov_b32 v22, 0
    v_mov_b32 v23, 0
    v_mov_b32 v24, 0
    v_mov_b32 v25, 0
    v_mov_b32 v26, 0
    v_mov_b32 v27, 0
    v_mov_b32 v28, 0
    v_mov_b32 v29, 0
    v_mov_b32 v30, 0
    v_mov_b32 v31, 0
    v_mov_b32 v32, 0
    v_mov_b32 v33, 0
    v_mov_b32 v34, 0
    v_mov_b32 v35, 0
    v_mov_b32 v36, 0
    v_mov_b32 v37, 0
    v_mov_b32 v38, 0
    v_mov_b32 v39, 0
    v_mov_b32 v40, 0
    v_mov_b32 v41, 0
    v_mov_b32 v42, 0
    v_mov_b32 v43, 0
    v_mov_b32 v44, 0
    v_mov_b32 v45, 0
    v_mov_b32 v46, 0
    v_mov_b32 v47, 0
    v_mov_b32 v48, 0
    v_mov_b32 v49, 0
    v_mov_b32 v50, 0
    v_mov_b32 v51, 0
    v_mov_b32 v52, 0
    v_mov_b32 v53, 0
    v_mov_b32 v54, 0
    v_mov_b32 v55, 0
    v_mov_b32 v56, 0
    v_mov_b32 v57, 0
    v_mov_b32 v58, 0
    v_mov_b32 v59, 0
    v_mov_b32 v60, 0
    v_mov_b32 v61, 0
    v_mov_b32 v62, 0
    v_mov_b32 v63, 0
    v_mov_b32 v64, 0
    v_mov_b32 v65, 0
    v_mov_b32 v66, 0
    v_mov_b32 v67, 0
    v_mov_b32 v68, 0
    v_mov_b32 v69, 0
    v_mov_b32 v70, 0
    v_mov_b32 v71, 0
    v_mov_b32 v72, 0
    v_mov_b32 v73, 0
    v_mov_b32 v74, 0
    v_mov_b32 v75, 0
    v_mov_b32 v76, 0
    v_mov_b32 v77, 0
    v_mov_b32 v78, 0
    v_mov_b32 v79, 0
    v_mov_b32 v80, 0
    v_mov_b32 v81, 0
    v_mov_b32 v82, 0
    v_mov_b32 v83, 0
    v_mov_b32 v84, 0
    v_mov_b32 v85, 0
    v_mov_b32 v86, 0
    v_mov_b32 v87, 0
    v_mov_b32 v88, 0
    v_mov_b32 v89, 0
    v_mov_b32 v90, 0
    v_mov_b32 v91, 0
    v_mov_b32 v92, 0
    v_mov_b32 v93, 0
    v_mov_b32 v94, 0
    v_mov_b32 v95, 0
    s_waitcnt vmcnt(8)
.p2align 3
    v_mfma_f32_16x16x32_bf16 v[16:19], v[112:115], v[132:135], v[16:19]
    v_mfma_f32_16x16x32_bf16 v[20:23], v[112:115], v[136:139], v[20:23]
    s_lshl_b32 s29, s34, 10
    s_add_u32 s29, s29, s53
    s_cmp_ge_u32 s34, s54
    s_cselect_b32 s31, 0x40000000, 0
    s_add_u32 s29, s29, s31
    s_add_u32 s34, s34, 1
    s_cmp_eq_u32 s34, 14
    s_cselect_b32 s34, 0, s34
    buffer_load_dwordx4 v[240:243], v7, s[16:19], s29 offen sc1
    v_mfma_f32_16x16x32_bf16 v[24:27], v[112:115], v[140:143], v[24:27]
    v_mfma_f32_16x16x32_bf16 v[28:31], v[112:115], v[144:147], v[28:31]
    buffer_load_dwordx4 v[244:247], v8, s[16:19], s29 offen sc1
    v_mfma_f32_16x16x32_bf16 v[32:35], v[116:119], v[132:135], v[32:35]
    v_mfma_f32_16x16x32_bf16 v[36:39], v[116:119], v[136:139], v[36:39]
    buffer_load_dwordx4 v[248:251], v9, s[16:19], s29 offen sc1
    v_mfma_f32_16x16x32_bf16 v[40:43], v[116:119], v[140:143], v[40:43]
    v_mfma_f32_16x16x32_bf16 v[44:47], v[116:119], v[144:147], v[44:47]
    buffer_load_dwordx4 v[252:255], v10, s[16:19], s29 offen sc1
    v_mfma_f32_16x16x32_bf16 v[48:51], v[120:123], v[132:135], v[48:51]
    v_mfma_f32_16x16x32_bf16 v[52:55], v[120:123], v[136:139], v[52:55]
    v_mfma_f32_16x16x32_bf16 v[56:59], v[120:123], v[140:143], v[56:59]
    v_mfma_f32_16x16x32_bf16 v[60:63], v[120:123], v[144:147], v[60:63]
    v_mfma_f32_16x16x32_bf16 v[64:67], v[124:127], v[132:135], v[64:67]
    v_mfma_f32_16x16x32_bf16 v[68:71], v[124:127], v[136:139], v[68:71]
    v_mfma_f32_16x16x32_bf16 v[72:75], v[124:127], v[140:143], v[72:75]
    v_mfma_f32_16x16x32_bf16 v[76:79], v[124:127], v[144:147], v[76:79]
    v_mfma_f32_16x16x32_bf16 v[80:83], v[128:131], v[132:135], v[80:83]
    v_mfma_f32_16x16x32_bf16 v[84:87], v[128:131], v[136:139], v[84:87]
    v_mfma_f32_16x16x32_bf16 v[88:91], v[128:131], v[140:143], v[88:91]
    v_mfma_f32_16x16x32_bf16 v[92:95], v[128:131], v[144:147], v[92:95]
    s_waitcnt vmcnt(8)
.p2align 3
    v_mfma_f32_16x16x32_bf16 v[16:19], v[148:151], v[168:171], v[16:19]
    v_mfma_f32_16x16x32_bf16 v[20:23], v[148:151], v[172:175], v[20:23]
    s_lshl_b32 s39, s33, 10
    s_add_u32 s39, s39, s52
    s_cmp_ge_u32 s33, s54
    s_cselect_b32 s31, 0x40000000, 0
    s_add_u32 s39, s39, s31
    s_add_u32 s33, s33, 1
    s_cmp_eq_u32 s33, 14
    s_cselect_b32 s33, 0, s33
    buffer_load_dwordx4 v[112:115], v104, s[16:19], s39 offen sc1
    v_mfma_f32_16x16x32_bf16 v[24:27], v[148:151], v[176:179], v[24:27]
    v_mfma_f32_16x16x32_bf16 v[28:31], v[148:151], v[180:183], v[28:31]
    buffer_load_dwordx4 v[116:119], v105, s[16:19], s39 offen sc1
    v_mfma_f32_16x16x32_bf16 v[32:35], v[152:155], v[168:171], v[32:35]
    v_mfma_f32_16x16x32_bf16 v[36:39], v[152:155], v[172:175], v[36:39]
    buffer_load_dwordx4 v[120:123], v106, s[16:19], s39 offen sc1
    v_mfma_f32_16x16x32_bf16 v[40:43], v[152:155], v[176:179], v[40:43]
    v_mfma_f32_16x16x32_bf16 v[44:47], v[152:155], v[180:183], v[44:47]
    buffer_load_dwordx4 v[124:127], v107, s[16:19], s39 offen sc1
    v_mfma_f32_16x16x32_bf16 v[48:51], v[156:159], v[168:171], v[48:51]
    v_mfma_f32_16x16x32_bf16 v[52:55], v[156:159], v[172:175], v[52:55]
    buffer_load_dwordx4 v[128:131], v108, s[16:19], s39 offen sc1
    v_mfma_f32_16x16x32_bf16 v[56:59], v[156:159], v[176:179], v[56:59]
    v_mfma_f32_16x16x32_bf16 v[60:63], v[156:159], v[180:183], v[60:63]
    s_lshl_b32 s29, s34, 10
    s_add_u32 s29, s29, s53
    s_cmp_ge_u32 s34, s54
    s_cselect_b32 s31, 0x40000000, 0
    s_add_u32 s29, s29, s31
    s_add_u32 s34, s34, 1
    s_cmp_eq_u32 s34, 14
    s_cselect_b32 s34, 0, s34
    buffer_load_dwordx4 v[132:135], v7, s[16:19], s29 offen sc1
    v_mfma_f32_16x16x32_bf16 v[64:67], v[160:163], v[168:171], v[64:67]
    v_mfma_f32_16x16x32_bf16 v[68:71], v[160:163], v[172:175], v[68:71]
    buffer_load_dwordx4 v[136:139], v8, s[16:19], s29 offen sc1
    v_mfma_f32_16x16x32_bf16 v[72:75], v[160:163], v[176:179], v[72:75]
    v_mfma_f32_16x16x32_bf16 v[76:79], v[160:163], v[180:183], v[76:79]
    buffer_load_dwordx4 v[140:143], v9, s[16:19], s29 offen sc1
    v_mfma_f32_16x16x32_bf16 v[80:83], v[164:167], v[168:171], v[80:83]
    v_mfma_f32_16x16x32_bf16 v[84:87], v[164:167], v[172:175], v[84:87]
    buffer_load_dwordx4 v[144:147], v10, s[16:19], s29 offen sc1
    v_mfma_f32_16x16x32_bf16 v[88:91], v[164:167], v[176:179], v[88:91]
    v_mfma_f32_16x16x32_bf16 v[92:95], v[164:167], v[180:183], v[92:95]
    s_waitcnt vmcnt(13)
.p2align 3
    v_mfma_f32_16x16x32_bf16 v[16:19], v[184:187], v[204:207], v[16:19]
    v_mfma_f32_16x16x32_bf16 v[20:23], v[184:187], v[208:211], v[20:23]
    s_lshl_b32 s39, s33, 10
    s_add_u32 s39, s39, s52
    s_cmp_ge_u32 s33, s54
    s_cselect_b32 s31, 0x40000000, 0
    s_add_u32 s39, s39, s31
    s_add_u32 s33, s33, 1
    s_cmp_eq_u32 s33, 14
    s_cselect_b32 s33, 0, s33
    buffer_load_dwordx4 v[148:151], v104, s[16:19], s39 offen sc1
    v_mfma_f32_16x16x32_bf16 v[24:27], v[184:187], v[212:215], v[24:27]
    v_mfma_f32_16x16x32_bf16 v[28:31], v[184:187], v[216:219], v[28:31]
    buffer_load_dwordx4 v[152:155], v105, s[16:19], s39 offen sc1
    v_mfma_f32_16x16x32_bf16 v[32:35], v[188:191], v[204:207], v[32:35]
    v_mfma_f32_16x16x32_bf16 v[36:39], v[188:191], v[208:211], v[36:39]
    buffer_load_dwordx4 v[156:159], v106, s[16:19], s39 offen sc1
    v_mfma_f32_16x16x32_bf16 v[40:43], v[188:191], v[212:215], v[40:43]
    v_mfma_f32_16x16x32_bf16 v[44:47], v[188:191], v[216:219], v[44:47]
    buffer_load_dwordx4 v[160:163], v107, s[16:19], s39 offen sc1
    v_mfma_f32_16x16x32_bf16 v[48:51], v[192:195], v[204:207], v[48:51]
    v_mfma_f32_16x16x32_bf16 v[52:55], v[192:195], v[208:211], v[52:55]
    buffer_load_dwordx4 v[164:167], v108, s[16:19], s39 offen sc1
    v_mfma_f32_16x16x32_bf16 v[56:59], v[192:195], v[212:215], v[56:59]
    v_mfma_f32_16x16x32_bf16 v[60:63], v[192:195], v[216:219], v[60:63]
    s_lshl_b32 s29, s34, 10
    s_add_u32 s29, s29, s53
    s_cmp_ge_u32 s34, s54
    s_cselect_b32 s31, 0x40000000, 0
    s_add_u32 s29, s29, s31
    s_add_u32 s34, s34, 1
    s_cmp_eq_u32 s34, 14
    s_cselect_b32 s34, 0, s34
    buffer_load_dwordx4 v[168:171], v7, s[16:19], s29 offen sc1
    v_mfma_f32_16x16x32_bf16 v[64:67], v[196:199], v[204:207], v[64:67]
    v_mfma_f32_16x16x32_bf16 v[68:71], v[196:199], v[208:211], v[68:71]
    buffer_load_dwordx4 v[172:175], v8, s[16:19], s29 offen sc1
    v_mfma_f32_16x16x32_bf16 v[72:75], v[196:199], v[212:215], v[72:75]
    v_mfma_f32_16x16x32_bf16 v[76:79], v[196:199], v[216:219], v[76:79]
    buffer_load_dwordx4 v[176:179], v9, s[16:19], s29 offen sc1
    v_mfma_f32_16x16x32_bf16 v[80:83], v[200:203], v[204:207], v[80:83]
    v_mfma_f32_16x16x32_bf16 v[84:87], v[200:203], v[208:211], v[84:87]
    buffer_load_dwordx4 v[180:183], v10, s[16:19], s29 offen sc1
    v_mfma_f32_16x16x32_bf16 v[88:91], v[200:203], v[212:215], v[88:91]
    v_mfma_f32_16x16x32_bf16 v[92:95], v[200:203], v[216:219], v[92:95]
    s_waitcnt vmcnt(18)
.p2align 3
    v_mfma_f32_16x16x32_bf16 v[16:19], v[220:223], v[240:243], v[16:19]
    v_mfma_f32_16x16x32_bf16 v[20:23], v[220:223], v[244:247], v[20:23]
    s_lshl_b32 s39, s33, 10
    s_add_u32 s39, s39, s52
    s_cmp_ge_u32 s33, s54
    s_cselect_b32 s31, 0x40000000, 0
    s_add_u32 s39, s39, s31
    s_add_u32 s33, s33, 1
    s_cmp_eq_u32 s33, 14
    s_cselect_b32 s33, 0, s33
    buffer_load_dwordx4 v[184:187], v104, s[16:19], s39 offen sc1
    v_mfma_f32_16x16x32_bf16 v[24:27], v[220:223], v[248:251], v[24:27]
    v_mfma_f32_16x16x32_bf16 v[28:31], v[220:223], v[252:255], v[28:31]
    buffer_load_dwordx4 v[188:191], v105, s[16:19], s39 offen sc1
    v_mfma_f32_16x16x32_bf16 v[32:35], v[224:227], v[240:243], v[32:35]
    v_mfma_f32_16x16x32_bf16 v[36:39], v[224:227], v[244:247], v[36:39]
    buffer_load_dwordx4 v[192:195], v106, s[16:19], s39 offen sc1
    v_mfma_f32_16x16x32_bf16 v[40:43], v[224:227], v[248:251], v[40:43]
    v_mfma_f32_16x16x32_bf16 v[44:47], v[224:227], v[252:255], v[44:47]
    buffer_load_dwordx4 v[196:199], v107, s[16:19], s39 offen sc1
    v_mfma_f32_16x16x32_bf16 v[48:51], v[228:231], v[240:243], v[48:51]
    v_mfma_f32_16x16x32_bf16 v[52:55], v[228:231], v[244:247], v[52:55]
    buffer_load_dwordx4 v[200:203], v108, s[16:19], s39 offen sc1
    v_mfma_f32_16x16x32_bf16 v[56:59], v[228:231], v[248:251], v[56:59]
    v_mfma_f32_16x16x32_bf16 v[60:63], v[228:231], v[252:255], v[60:63]
    s_lshl_b32 s29, s34, 10
    s_add_u32 s29, s29, s53
    s_cmp_ge_u32 s34, s54
    s_cselect_b32 s31, 0x40000000, 0
    s_add_u32 s29, s29, s31
    s_add_u32 s34, s34, 1
    s_cmp_eq_u32 s34, 14
    s_cselect_b32 s34, 0, s34
    buffer_load_dwordx4 v[204:207], v7, s[16:19], s29 offen sc1
    v_mfma_f32_16x16x32_bf16 v[64:67], v[232:235], v[240:243], v[64:67]
    v_mfma_f32_16x16x32_bf16 v[68:71], v[232:235], v[244:247], v[68:71]
    buffer_load_dwordx4 v[208:211], v8, s[16:19], s29 offen sc1
    v_mfma_f32_16x16x32_bf16 v[72:75], v[232:235], v[248:251], v[72:75]
    v_mfma_f32_16x16x32_bf16 v[76:79], v[232:235], v[252:255], v[76:79]
    buffer_load_dwordx4 v[212:215], v9, s[16:19], s29 offen sc1
    v_mfma_f32_16x16x32_bf16 v[80:83], v[236:239], v[240:243], v[80:83]
    v_mfma_f32_16x16x32_bf16 v[84:87], v[236:239], v[244:247], v[84:87]
    buffer_load_dwordx4 v[216:219], v10, s[16:19], s29 offen sc1
    v_mfma_f32_16x16x32_bf16 v[88:91], v[236:239], v[248:251], v[88:91]
    v_mfma_f32_16x16x32_bf16 v[92:95], v[236:239], v[252:255], v[92:95]
    s_waitcnt vmcnt(18)
.p2align 3
    v_mfma_f32_16x16x32_bf16 v[16:19], v[112:115], v[132:135], v[16:19]
    v_mfma_f32_16x16x32_bf16 v[20:23], v[112:115], v[136:139], v[20:23]
    s_lshl_b32 s39, s33, 10
    s_add_u32 s39, s39, s52
    s_cmp_ge_u32 s33, s54
    s_cselect_b32 s31, 0x40000000, 0
    s_add_u32 s39, s39, s31
    s_add_u32 s33, s33, 1
    s_cmp_eq_u32 s33, 14
    s_cselect_b32 s33, 0, s33
    buffer_load_dwordx4 v[220:223], v104, s[16:19], s39 offen sc1
    v_mfma_f32_16x16x32_bf16 v[24:27], v[112:115], v[140:143], v[24:27]
    v_mfma_f32_16x16x32_bf16 v[28:31], v[112:115], v[144:147], v[28:31]
    buffer_load_dwordx4 v[224:227], v105, s[16:19], s39 offen sc1
    v_mfma_f32_16x16x32_bf16 v[32:35], v[116:119], v[132:135], v[32:35]
    v_mfma_f32_16x16x32_bf16 v[36:39], v[116:119], v[136:139], v[36:39]
    buffer_load_dwordx4 v[228:231], v106, s[16:19], s39 offen sc1
    v_mfma_f32_16x16x32_bf16 v[40:43], v[116:119], v[140:143], v[40:43]
    v_mfma_f32_16x16x32_bf16 v[44:47], v[116:119], v[144:147], v[44:47]
    buffer_load_dwordx4 v[232:235], v107, s[16:19], s39 offen sc1
    v_mfma_f32_16x16x32_bf16 v[48:51], v[120:123], v[132:135], v[48:51]
    v_mfma_f32_16x16x32_bf16 v[52:55], v[120:123], v[136:139], v[52:55]
    buffer_load_dwordx4 v[236:239], v108, s[16:19], s39 offen sc1
    v_mfma_f32_16x16x32_bf16 v[56:59], v[120:123], v[140:143], v[56:59]
    v_mfma_f32_16x16x32_bf16 v[60:63], v[120:123], v[144:147], v[60:63]
    s_lshl_b32 s29, s34, 10
    s_add_u32 s29, s29, s53
    s_cmp_ge_u32 s34, s54
    s_cselect_b32 s31, 0x40000000, 0
    s_add_u32 s29, s29, s31
    s_add_u32 s34, s34, 1
    s_cmp_eq_u32 s34, 14
    s_cselect_b32 s34, 0, s34
    buffer_load_dwordx4 v[240:243], v7, s[16:19], s29 offen sc1
    v_mfma_f32_16x16x32_bf16 v[64:67], v[124:127], v[132:135], v[64:67]
    v_mfma_f32_16x16x32_bf16 v[68:71], v[124:127], v[136:139], v[68:71]
    buffer_load_dwordx4 v[244:247], v8, s[16:19], s29 offen sc1
    v_mfma_f32_16x16x32_bf16 v[72:75], v[124:127], v[140:143], v[72:75]
    v_mfma_f32_16x16x32_bf16 v[76:79], v[124:127], v[144:147], v[76:79]
    buffer_load_dwordx4 v[248:251], v9, s[16:19], s29 offen sc1
    v_mfma_f32_16x16x32_bf16 v[80:83], v[128:131], v[132:135], v[80:83]
    v_mfma_f32_16x16x32_bf16 v[84:87], v[128:131], v[136:139], v[84:87]
    buffer_load_dwordx4 v[252:255], v10, s[16:19], s29 offen sc1
    v_mfma_f32_16x16x32_bf16 v[88:91], v[128:131], v[140:143], v[88:91]
    v_mfma_f32_16x16x32_bf16 v[92:95], v[128:131], v[144:147], v[92:95]
    s_waitcnt vmcnt(18)
.p2align 3
    v_mfma_f32_16x16x32_bf16 v[16:19], v[148:151], v[168:171], v[16:19]
    v_mfma_f32_16x16x32_bf16 v[20:23], v[148:151], v[172:175], v[20:23]
    s_lshl_b32 s39, s33, 10
    s_add_u32 s39, s39, s52
    s_cmp_ge_u32 s33, s54
    s_cselect_b32 s31, 0x40000000, 0
    s_add_u32 s39, s39, s31
    s_add_u32 s33, s33, 1
    s_cmp_eq_u32 s33, 14
    s_cselect_b32 s33, 0, s33
    buffer_load_dwordx4 v[112:115], v104, s[16:19], s39 offen sc1
    v_mfma_f32_16x16x32_bf16 v[24:27], v[148:151], v[176:179], v[24:27]
    v_mfma_f32_16x16x32_bf16 v[28:31], v[148:151], v[180:183], v[28:31]
    buffer_load_dwordx4 v[116:119], v105, s[16:19], s39 offen sc1
    v_mfma_f32_16x16x32_bf16 v[32:35], v[152:155], v[168:171], v[32:35]
    v_mfma_f32_16x16x32_bf16 v[36:39], v[152:155], v[172:175], v[36:39]
    buffer_load_dwordx4 v[120:123], v106, s[16:19], s39 offen sc1
    v_mfma_f32_16x16x32_bf16 v[40:43], v[152:155], v[176:179], v[40:43]
    v_mfma_f32_16x16x32_bf16 v[44:47], v[152:155], v[180:183], v[44:47]
    buffer_load_dwordx4 v[124:127], v107, s[16:19], s39 offen sc1
    v_mfma_f32_16x16x32_bf16 v[48:51], v[156:159], v[168:171], v[48:51]
    v_mfma_f32_16x16x32_bf16 v[52:55], v[156:159], v[172:175], v[52:55]
    buffer_load_dwordx4 v[128:131], v108, s[16:19], s39 offen sc1
    v_mfma_f32_16x16x32_bf16 v[56:59], v[156:159], v[176:179], v[56:59]
    v_mfma_f32_16x16x32_bf16 v[60:63], v[156:159], v[180:183], v[60:63]
    s_lshl_b32 s29, s34, 10
    s_add_u32 s29, s29, s53
    s_cmp_ge_u32 s34, s54
    s_cselect_b32 s31, 0x40000000, 0
    s_add_u32 s29, s29, s31
    s_add_u32 s34, s34, 1
    s_cmp_eq_u32 s34, 14
    s_cselect_b32 s34, 0, s34
    buffer_load_dwordx4 v[132:135], v7, s[16:19], s29 offen sc1
    v_mfma_f32_16x16x32_bf16 v[64:67], v[160:163], v[168:171], v[64:67]
    v_mfma_f32_16x16x32_bf16 v[68:71], v[160:163], v[172:175], v[68:71]
    buffer_load_dwordx4 v[136:139], v8, s[16:19], s29 offen sc1
    v_mfma_f32_16x16x32_bf16 v[72:75], v[160:163], v[176:179], v[72:75]
    v_mfma_f32_16x16x32_bf16 v[76:79], v[160:163], v[180:183], v[76:79]
    buffer_load_dwordx4 v[140:143], v9, s[16:19], s29 offen sc1
    v_mfma_f32_16x16x32_bf16 v[80:83], v[164:167], v[168:171], v[80:83]
    v_mfma_f32_16x16x32_bf16 v[84:87], v[164:167], v[172:175], v[84:87]
    buffer_load_dwordx4 v[144:147], v10, s[16:19], s29 offen sc1
    v_mfma_f32_16x16x32_bf16 v[88:91], v[164:167], v[176:179], v[88:91]
    v_mfma_f32_16x16x32_bf16 v[92:95], v[164:167], v[180:183], v[92:95]
    s_waitcnt vmcnt(18)
.p2align 3
    v_mfma_f32_16x16x32_bf16 v[16:19], v[184:187], v[204:207], v[16:19]
    v_mfma_f32_16x16x32_bf16 v[20:23], v[184:187], v[208:211], v[20:23]
    s_lshl_b32 s39, s33, 10
    s_add_u32 s39, s39, s52
    s_cmp_ge_u32 s33, s54
    s_cselect_b32 s31, 0x40000000, 0
    s_add_u32 s39, s39, s31
    s_add_u32 s33, s33, 1
    s_cmp_eq_u32 s33, 14
    s_cselect_b32 s33, 0, s33
    buffer_load_dwordx4 v[148:151], v104, s[16:19], s39 offen sc1
    v_mfma_f32_16x16x32_bf16 v[24:27], v[184:187], v[212:215], v[24:27]
    v_mfma_f32_16x16x32_bf16 v[28:31], v[184:187], v[216:219], v[28:31]
    buffer_load_dwordx4 v[152:155], v105, s[16:19], s39 offen sc1
    v_mfma_f32_16x16x32_bf16 v[32:35], v[188:191], v[204:207], v[32:35]
    v_mfma_f32_16x16x32_bf16 v[36:39], v[188:191], v[208:211], v[36:39]
    buffer_load_dwordx4 v[156:159], v106, s[16:19], s39 offen sc1
    v_mfma_f32_16x16x32_bf16 v[40:43], v[188:191], v[212:215], v[40:43]
    v_mfma_f32_16x16x32_bf16 v[44:47], v[188:191], v[216:219], v[44:47]
    buffer_load_dwordx4 v[160:163], v107, s[16:19], s39 offen sc1
    v_mfma_f32_16x16x32_bf16 v[48:51], v[192:195], v[204:207], v[48:51]
    v_mfma_f32_16x16x32_bf16 v[52:55], v[192:195], v[208:211], v[52:55]
    buffer_load_dwordx4 v[164:167], v108, s[16:19], s39 offen sc1
    v_mfma_f32_16x16x32_bf16 v[56:59], v[192:195], v[212:215], v[56:59]
    v_mfma_f32_16x16x32_bf16 v[60:63], v[192:195], v[216:219], v[60:63]
    s_lshl_b32 s29, s34, 10
    s_add_u32 s29, s29, s53
    s_cmp_ge_u32 s34, s54
    s_cselect_b32 s31, 0x40000000, 0
    s_add_u32 s29, s29, s31
    s_add_u32 s34, s34, 1
    s_cmp_eq_u32 s34, 14
    s_cselect_b32 s34, 0, s34
    buffer_load_dwordx4 v[168:171], v7, s[16:19], s29 offen sc1
    v_mfma_f32_16x16x32_bf16 v[64:67], v[196:199], v[204:207], v[64:67]
    v_mfma_f32_16x16x32_bf16 v[68:71], v[196:199], v[208:211], v[68:71]
    buffer_load_dwordx4 v[172:175], v8, s[16:19], s29 offen sc1
    v_mfma_f32_16x16x32_bf16 v[72:75], v[196:199], v[212:215], v[72:75]
    v_mfma_f32_16x16x32_bf16 v[76:79], v[196:199], v[216:219], v[76:79]
    buffer_load_dwordx4 v[176:179], v9, s[16:19], s29 offen sc1
    v_mfma_f32_16x16x32_bf16 v[80:83], v[200:203], v[204:207], v[80:83]
    v_mfma_f32_16x16x32_bf16 v[84:87], v[200:203], v[208:211], v[84:87]
    buffer_load_dwordx4 v[180:183], v10, s[16:19], s29 offen sc1
    v_mfma_f32_16x16x32_bf16 v[88:91], v[200:203], v[212:215], v[88:91]
    v_mfma_f32_16x16x32_bf16 v[92:95], v[200:203], v[216:219], v[92:95]
    s_waitcnt vmcnt(18)
.p2align 3
    v_mfma_f32_16x16x32_bf16 v[16:19], v[220:223], v[240:243], v[16:19]
    v_mfma_f32_16x16x32_bf16 v[20:23], v[220:223], v[244:247], v[20:23]
    s_lshl_b32 s39, s33, 10
    s_add_u32 s39, s39, s52
    s_cmp_ge_u32 s33, s54
    s_cselect_b32 s31, 0x40000000, 0
    s_add_u32 s39, s39, s31
    s_add_u32 s33, s33, 1
    s_cmp_eq_u32 s33, 14
    s_cselect_b32 s33, 0, s33
    buffer_load_dwordx4 v[184:187], v104, s[16:19], s39 offen sc1
    v_mfma_f32_16x16x32_bf16 v[24:27], v[220:223], v[248:251], v[24:27]
    v_mfma_f32_16x16x32_bf16 v[28:31], v[220:223], v[252:255], v[28:31]
    buffer_load_dwordx4 v[188:191], v105, s[16:19], s39 offen sc1
    v_mfma_f32_16x16x32_bf16 v[32:35], v[224:227], v[240:243], v[32:35]
    v_mfma_f32_16x16x32_bf16 v[36:39], v[224:227], v[244:247], v[36:39]
    buffer_load_dwordx4 v[192:195], v106, s[16:19], s39 offen sc1
    v_mfma_f32_16x16x32_bf16 v[40:43], v[224:227], v[248:251], v[40:43]
    v_mfma_f32_16x16x32_bf16 v[44:47], v[224:227], v[252:255], v[44:47]
    buffer_load_dwordx4 v[196:199], v107, s[16:19], s39 offen sc1
    v_mfma_f32_16x16x32_bf16 v[48:51], v[228:231], v[240:243], v[48:51]
    v_mfma_f32_16x16x32_bf16 v[52:55], v[228:231], v[244:247], v[52:55]
    buffer_load_dwordx4 v[200:203], v108, s[16:19], s39 offen sc1
    v_mfma_f32_16x16x32_bf16 v[56:59], v[228:231], v[248:251], v[56:59]
    v_mfma_f32_16x16x32_bf16 v[60:63], v[228:231], v[252:255], v[60:63]
    s_lshl_b32 s29, s34, 10
    s_add_u32 s29, s29, s53
    s_cmp_ge_u32 s34, s54
    s_cselect_b32 s31, 0x40000000, 0
    s_add_u32 s29, s29, s31
    s_add_u32 s34, s34, 1
    s_cmp_eq_u32 s34, 14
    s_cselect_b32 s34, 0, s34
    buffer_load_dwordx4 v[204:207], v7, s[16:19], s29 offen sc1
    v_mfma_f32_16x16x32_bf16 v[64:67], v[232:235], v[240:243], v[64:67]
    v_mfma_f32_16x16x32_bf16 v[68:71], v[232:235], v[244:247], v[68:71]
    buffer_load_dwordx4 v[208:211], v8, s[16:19], s29 offen sc1
    v_mfma_f32_16x16x32_bf16 v[72:75], v[232:235], v[248:251], v[72:75]
    v_mfma_f32_16x16x32_bf16 v[76:79], v[232:235], v[252:255], v[76:79]
    buffer_load_dwordx4 v[212:215], v9, s[16:19], s29 offen sc1
    v_mfma_f32_16x16x32_bf16 v[80:83], v[236:239], v[240:243], v[80:83]
    v_mfma_f32_16x16x32_bf16 v[84:87], v[236:239], v[244:247], v[84:87]
    buffer_load_dwordx4 v[216:219], v10, s[16:19], s29 offen sc1
    v_mfma_f32_16x16x32_bf16 v[88:91], v[236:239], v[248:251], v[88:91]
    v_mfma_f32_16x16x32_bf16 v[92:95], v[236:239], v[252:255], v[92:95]
    v_mov_b32 v96, 163804
    v_mov_b32 v97, 1
    ds_write_b32 v96, v97
    s_waitcnt vmcnt(18)
.p2align 3
    v_mfma_f32_16x16x32_bf16 v[16:19], v[112:115], v[132:135], v[16:19]
    v_mfma_f32_16x16x32_bf16 v[20:23], v[112:115], v[136:139], v[20:23]
    s_lshl_b32 s39, s33, 10
    s_add_u32 s39, s39, s52
    s_cmp_ge_u32 s33, s54
    s_cselect_b32 s31, 0x40000000, 0
    s_add_u32 s39, s39, s31
    s_add_u32 s33, s33, 1
    s_cmp_eq_u32 s33, 14
    s_cselect_b32 s33, 0, s33
    buffer_load_dwordx4 v[220:223], v104, s[16:19], s39 offen sc1
    v_mfma_f32_16x16x32_bf16 v[24:27], v[112:115], v[140:143], v[24:27]
    v_mfma_f32_16x16x32_bf16 v[28:31], v[112:115], v[144:147], v[28:31]
    buffer_load_dwordx4 v[224:227], v105, s[16:19], s39 offen sc1
    v_mfma_f32_16x16x32_bf16 v[32:35], v[116:119], v[132:135], v[32:35]
    v_mfma_f32_16x16x32_bf16 v[36:39], v[116:119], v[136:139], v[36:39]
    buffer_load_dwordx4 v[228:231], v106, s[16:19], s39 offen sc1
    v_mfma_f32_16x16x32_bf16 v[40:43], v[116:119], v[140:143], v[40:43]
    v_mfma_f32_16x16x32_bf16 v[44:47], v[116:119], v[144:147], v[44:47]
    buffer_load_dwordx4 v[232:235], v107, s[16:19], s39 offen sc1
    v_mfma_f32_16x16x32_bf16 v[48:51], v[120:123], v[132:135], v[48:51]
    v_mfma_f32_16x16x32_bf16 v[52:55], v[120:123], v[136:139], v[52:55]
    buffer_load_dwordx4 v[236:239], v108, s[16:19], s39 offen sc1
    v_mfma_f32_16x16x32_bf16 v[56:59], v[120:123], v[140:143], v[56:59]
    v_mfma_f32_16x16x32_bf16 v[60:63], v[120:123], v[144:147], v[60:63]
    s_lshl_b32 s29, s34, 10
    s_add_u32 s29, s29, s53
    s_cmp_ge_u32 s34, s54
    s_cselect_b32 s31, 0x40000000, 0
    s_add_u32 s29, s29, s31
    s_add_u32 s34, s34, 1
    s_cmp_eq_u32 s34, 14
    s_cselect_b32 s34, 0, s34
    buffer_load_dwordx4 v[240:243], v7, s[16:19], s29 offen sc1
    v_mfma_f32_16x16x32_bf16 v[64:67], v[124:127], v[132:135], v[64:67]
    v_mfma_f32_16x16x32_bf16 v[68:71], v[124:127], v[136:139], v[68:71]
    buffer_load_dwordx4 v[244:247], v8, s[16:19], s29 offen sc1
    v_mfma_f32_16x16x32_bf16 v[72:75], v[124:127], v[140:143], v[72:75]
    v_mfma_f32_16x16x32_bf16 v[76:79], v[124:127], v[144:147], v[76:79]
    buffer_load_dwordx4 v[248:251], v9, s[16:19], s29 offen sc1
    v_mfma_f32_16x16x32_bf16 v[80:83], v[128:131], v[132:135], v[80:83]
    v_mfma_f32_16x16x32_bf16 v[84:87], v[128:131], v[136:139], v[84:87]
    buffer_load_dwordx4 v[252:255], v10, s[16:19], s29 offen sc1
    v_mfma_f32_16x16x32_bf16 v[88:91], v[128:131], v[140:143], v[88:91]
    v_mfma_f32_16x16x32_bf16 v[92:95], v[128:131], v[144:147], v[92:95]
    s_waitcnt vmcnt(18)
.p2align 3
    v_mfma_f32_16x16x32_bf16 v[16:19], v[148:151], v[168:171], v[16:19]
    v_mfma_f32_16x16x32_bf16 v[20:23], v[148:151], v[172:175], v[20:23]
    s_lshl_b32 s39, s33, 10
    s_add_u32 s39, s39, s52
    s_cmp_ge_u32 s33, s54
    s_cselect_b32 s31, 0x40000000, 0
    s_add_u32 s39, s39, s31
    s_add_u32 s33, s33, 1
    s_cmp_eq_u32 s33, 14
    s_cselect_b32 s33, 0, s33
    buffer_load_dwordx4 v[112:115], v104, s[16:19], s39 offen sc1
    v_mfma_f32_16x16x32_bf16 v[24:27], v[148:151], v[176:179], v[24:27]
    v_mfma_f32_16x16x32_bf16 v[28:31], v[148:151], v[180:183], v[28:31]
    buffer_load_dwordx4 v[116:119], v105, s[16:19], s39 offen sc1
    v_mfma_f32_16x16x32_bf16 v[32:35], v[152:155], v[168:171], v[32:35]
    v_mfma_f32_16x16x32_bf16 v[36:39], v[152:155], v[172:175], v[36:39]
    buffer_load_dwordx4 v[120:123], v106, s[16:19], s39 offen sc1
    v_mfma_f32_16x16x32_bf16 v[40:43], v[152:155], v[176:179], v[40:43]
    v_mfma_f32_16x16x32_bf16 v[44:47], v[152:155], v[180:183], v[44:47]
    buffer_load_dwordx4 v[124:127], v107, s[16:19], s39 offen sc1
    v_mfma_f32_16x16x32_bf16 v[48:51], v[156:159], v[168:171], v[48:51]
    v_mfma_f32_16x16x32_bf16 v[52:55], v[156:159], v[172:175], v[52:55]
    buffer_load_dwordx4 v[128:131], v108, s[16:19], s39 offen sc1
    v_mfma_f32_16x16x32_bf16 v[56:59], v[156:159], v[176:179], v[56:59]
    v_mfma_f32_16x16x32_bf16 v[60:63], v[156:159], v[180:183], v[60:63]
    s_lshl_b32 s29, s34, 10
    s_add_u32 s29, s29, s53
    s_cmp_ge_u32 s34, s54
    s_cselect_b32 s31, 0x40000000, 0
    s_add_u32 s29, s29, s31
    s_add_u32 s34, s34, 1
    s_cmp_eq_u32 s34, 14
    s_cselect_b32 s34, 0, s34
    buffer_load_dwordx4 v[132:135], v7, s[16:19], s29 offen sc1
    v_mfma_f32_16x16x32_bf16 v[64:67], v[160:163], v[168:171], v[64:67]
    v_mfma_f32_16x16x32_bf16 v[68:71], v[160:163], v[172:175], v[68:71]
    buffer_load_dwordx4 v[136:139], v8, s[16:19], s29 offen sc1
    v_mfma_f32_16x16x32_bf16 v[72:75], v[160:163], v[176:179], v[72:75]
    v_mfma_f32_16x16x32_bf16 v[76:79], v[160:163], v[180:183], v[76:79]
    buffer_load_dwordx4 v[140:143], v9, s[16:19], s29 offen sc1
    v_mfma_f32_16x16x32_bf16 v[80:83], v[164:167], v[168:171], v[80:83]
    v_mfma_f32_16x16x32_bf16 v[84:87], v[164:167], v[172:175], v[84:87]
    buffer_load_dwordx4 v[144:147], v10, s[16:19], s29 offen sc1
    v_mfma_f32_16x16x32_bf16 v[88:91], v[164:167], v[176:179], v[88:91]
    v_mfma_f32_16x16x32_bf16 v[92:95], v[164:167], v[180:183], v[92:95]
    s_waitcnt vmcnt(18)
.p2align 3
    v_mfma_f32_16x16x32_bf16 v[16:19], v[184:187], v[204:207], v[16:19]
    v_mfma_f32_16x16x32_bf16 v[20:23], v[184:187], v[208:211], v[20:23]
    s_lshl_b32 s39, s33, 10
    s_add_u32 s39, s39, s52
    s_cmp_ge_u32 s33, s54
    s_cselect_b32 s31, 0x40000000, 0
    s_add_u32 s39, s39, s31
    s_add_u32 s33, s33, 1
    s_cmp_eq_u32 s33, 14
    s_cselect_b32 s33, 0, s33
    buffer_load_dwordx4 v[148:151], v104, s[16:19], s39 offen sc1
    v_mfma_f32_16x16x32_bf16 v[24:27], v[184:187], v[212:215], v[24:27]
    v_mfma_f32_16x16x32_bf16 v[28:31], v[184:187], v[216:219], v[28:31]
    buffer_load_dwordx4 v[152:155], v105, s[16:19], s39 offen sc1
    v_mfma_f32_16x16x32_bf16 v[32:35], v[188:191], v[204:207], v[32:35]
    v_mfma_f32_16x16x32_bf16 v[36:39], v[188:191], v[208:211], v[36:39]
    buffer_load_dwordx4 v[156:159], v106, s[16:19], s39 offen sc1
    v_mfma_f32_16x16x32_bf16 v[40:43], v[188:191], v[212:215], v[40:43]
    v_mfma_f32_16x16x32_bf16 v[44:47], v[188:191], v[216:219], v[44:47]
    buffer_load_dwordx4 v[160:163], v107, s[16:19], s39 offen sc1
    v_mfma_f32_16x16x32_bf16 v[48:51], v[192:195], v[204:207], v[48:51]
    v_mfma_f32_16x16x32_bf16 v[52:55], v[192:195], v[208:211], v[52:55]
    buffer_load_dwordx4 v[164:167], v108, s[16:19], s39 offen sc1
    v_mfma_f32_16x16x32_bf16 v[56:59], v[192:195], v[212:215], v[56:59]
    v_mfma_f32_16x16x32_bf16 v[60:63], v[192:195], v[216:219], v[60:63]
    s_lshl_b32 s29, s34, 10
    s_add_u32 s29, s29, s53
    s_cmp_ge_u32 s34, s54
    s_cselect_b32 s31, 0x40000000, 0
    s_add_u32 s29, s29, s31
    s_add_u32 s34, s34, 1
    s_cmp_eq_u32 s34, 14
    s_cselect_b32 s34, 0, s34
    buffer_load_dwordx4 v[168:171], v7, s[16:19], s29 offen sc1
    v_mfma_f32_16x16x32_bf16 v[64:67], v[196:199], v[204:207], v[64:67]
    v_mfma_f32_16x16x32_bf16 v[68:71], v[196:199], v[208:211], v[68:71]
    buffer_load_dwordx4 v[172:175], v8, s[16:19], s29 offen sc1
    v_mfma_f32_16x16x32_bf16 v[72:75], v[196:199], v[212:215], v[72:75]
    v_mfma_f32_16x16x32_bf16 v[76:79], v[196:199], v[216:219], v[76:79]
    buffer_load_dwordx4 v[176:179], v9, s[16:19], s29 offen sc1
    v_mfma_f32_16x16x32_bf16 v[80:83], v[200:203], v[204:207], v[80:83]
    v_mfma_f32_16x16x32_bf16 v[84:87], v[200:203], v[208:211], v[84:87]
    buffer_load_dwordx4 v[180:183], v10, s[16:19], s29 offen sc1
    v_mfma_f32_16x16x32_bf16 v[88:91], v[200:203], v[212:215], v[88:91]
    v_mfma_f32_16x16x32_bf16 v[92:95], v[200:203], v[216:219], v[92:95]
    v_and_b32 v11, 15, v1
    v_lshrrev_b32 v12, 4, v1
    s_lshl_b32 s35, s40, 6
    s_lshl_b32 s36, s28, 4
    s_add_u32 s35, s35, s36
    v_add_u32 v13, s35, v11
    s_movk_i32 s36, 1280
    v_mul_lo_u32 v13, v13, s36
    v_lshl_add_u32 v13, v12, 3, v13
    s_mul_i32 s36, s41, 160
    v_lshlrev_b32 v14, 3, v12
    buffer_load_dwordx2 v[184:185], v13, s[8:11], s36 offen offset:0
    buffer_load_dwordx2 v[186:187], v13, s[8:11], s36 offen offset:32
    buffer_load_dwordx2 v[188:189], v13, s[8:11], s36 offen offset:64
    buffer_load_dwordx2 v[190:191], v13, s[8:11], s36 offen offset:96
    buffer_load_dwordx2 v[192:193], v13, s[8:11], s36 offen offset:128
    buffer_load_dwordx2 v[194:195], v14, s[12:15], s36 offen offset:0
    buffer_load_dwordx2 v[196:197], v14, s[12:15], s36 offen offset:32
    buffer_load_dwordx2 v[198:199], v14, s[12:15], s36 offen offset:64
    buffer_load_dwordx2 v[200:201], v14, s[12:15], s36 offen offset:96
    buffer_load_dwordx2 v[202:203], v14, s[12:15], s36 offen offset:128
    v_mov_b32 v96, 163800
lw18:
    ds_read_b32 v97, v96
    s_waitcnt lgkmcnt(0)
    v_readfirstlane_b32 s30, v97
    s_nop 3
    s_cmp_eq_u32 s30, 1
    s_cbranch_scc1 lw_ok18
    s_sleep 1
    s_branch lw18
lw_ok18:
    v_lshrrev_b32 v15, 1, v1
    v_mul_u32_u24 v15, 4224, v15
    v_and_b32 v11, 1, v1
    v_lshl_add_u32 v15, v11, 4, v15
    s_mul_i32 s37, s41, 337920
    s_lshl_b32 s38, s35, 1
    s_add_u32 s37, s37, s38
    s_add_u32 s37, s37, 12582912
    buffer_load_dwordx4 v[204:207], v15, s[16:19], s37 offen sc1
    s_add_u32 s38, s37, 135168
    buffer_load_dwordx4 v[208:211], v15, s[16:19], s38 offen sc1
    s_add_u32 s38, s37, 270336
    s_mov_b32 exec_hi, 0
    buffer_load_dwordx4 v[212:215], v15, s[16:19], s38 offen sc1
    s_mov_b32 exec_hi, -1
    s_waitcnt vmcnt(31)
.p2align 3
    v_mfma_f32_16x16x32_bf16 v[16:19], v[220:223], v[240:243], v[16:19]
    v_mfma_f32_16x16x32_bf16 v[20:23], v[220:223], v[244:247], v[20:23]
    v_mfma_f32_16x16x32_bf16 v[24:27], v[220:223], v[248:251], v[24:27]
    v_mfma_f32_16x16x32_bf16 v[28:31], v[220:223], v[252:255], v[28:31]
    v_mfma_f32_16x16x32_bf16 v[32:35], v[224:227], v[240:243], v[32:35]
    v_mfma_f32_16x16x32_bf16 v[36:39], v[224:227], v[244:247], v[36:39]
    v_mfma_f32_16x16x32_bf16 v[40:43], v[224:227], v[248:251], v[40:43]
    v_mfma_f32_16x16x32_bf16 v[44:47], v[224:227], v[252:255], v[44:47]
    v_mfma_f32_16x16x32_bf16 v[48:51], v[228:231], v[240:243], v[48:51]
    v_mfma_f32_16x16x32_bf16 v[52:55], v[228:231], v[244:247], v[52:55]
    v_mfma_f32_16x16x32_bf16 v[56:59], v[228:231], v[248:251], v[56:59]
    v_mfma_f32_16x16x32_bf16 v[60:63], v[228:231], v[252:255], v[60:63]
    v_mfma_f32_16x16x32_bf16 v[64:67], v[232:235], v[240:243], v[64:67]
    v_mfma_f32_16x16x32_bf16 v[68:71], v[232:235], v[244:247], v[68:71]
    v_mfma_f32_16x16x32_bf16 v[72:75], v[232:235], v[248:251], v[72:75]
    v_mfma_f32_16x16x32_bf16 v[76:79], v[232:235], v[252:255], v[76:79]
    v_mfma_f32_16x16x32_bf16 v[80:83], v[236:239], v[240:243], v[80:83]
    v_mfma_f32_16x16x32_bf16 v[84:87], v[236:239], v[244:247], v[84:87]
    v_mfma_f32_16x16x32_bf16 v[88:91], v[236:239], v[248:251], v[88:91]
    v_mfma_f32_16x16x32_bf16 v[92:95], v[236:239], v[252:255], v[92:95]
    s_waitcnt vmcnt(22)
.p2align 3
    v_mfma_f32_16x16x32_bf16 v[16:19], v[112:115], v[132:135], v[16:19]
    v_mfma_f32_16x16x32_bf16 v[20:23], v[112:115], v[136:139], v[20:23]
    v_mfma_f32_16x16x32_bf16 v[24:27], v[112:115], v[140:143], v[24:27]
    v_mfma_f32_16x16x32_bf16 v[28:31], v[112:115], v[144:147], v[28:31]
    v_mfma_f32_16x16x32_bf16 v[32:35], v[116:119], v[132:135], v[32:35]
    v_mfma_f32_16x16x32_bf16 v[36:39], v[116:119], v[136:139], v[36:39]
    v_mfma_f32_16x16x32_bf16 v[40:43], v[116:119], v[140:143], v[40:43]
    v_mfma_f32_16x16x32_bf16 v[44:47], v[116:119], v[144:147], v[44:47]
    v_mfma_f32_16x16x32_bf16 v[48:51], v[120:123], v[132:135], v[48:51]
    v_mfma_f32_16x16x32_bf16 v[52:55], v[120:123], v[136:139], v[52:55]
    v_mfma_f32_16x16x32_bf16 v[56:59], v[120:123], v[140:143], v[56:59]
    v_mfma_f32_16x16x32_bf16 v[60:63], v[120:123], v[144:147], v[60:63]
    v_mfma_f32_16x16x32_bf16 v[64:67], v[124:127], v[132:135], v[64:67]
    v_mfma_f32_16x16x32_bf16 v[68:71], v[124:127], v[136:139], v[68:71]
    v_mfma_f32_16x16x32_bf16 v[72:75], v[124:127], v[140:143], v[72:75]
    v_mfma_f32_16x16x32_bf16 v[76:79], v[124:127], v[144:147], v[76:79]
    v_mfma_f32_16x16x32_bf16 v[80:83], v[128:131], v[132:135], v[80:83]
    v_mfma_f32_16x16x32_bf16 v[84:87], v[128:131], v[136:139], v[84:87]
    v_mfma_f32_16x16x32_bf16 v[88:91], v[128:131], v[140:143], v[88:91]
    v_mfma_f32_16x16x32_bf16 v[92:95], v[128:131], v[144:147], v[92:95]
    s_waitcnt vmcnt(13)
.p2align 3
    v_mfma_f32_16x16x32_bf16 v[16:19], v[148:151], v[168:171], v[16:19]
    v_mfma_f32_16x16x32_bf16 v[20:23], v[148:151], v[172:175], v[20:23]
    v_mfma_f32_16x16x32_bf16 v[24:27], v[148:151], v[176:179], v[24:27]
    v_mfma_f32_16x16x32_bf16 v[28:31], v[148:151], v[180:183], v[28:31]
    v_mfma_f32_16x16x32_bf16 v[32:35], v[152:155], v[168:171], v[32:35]
    v_mfma_f32_16x16x32_bf16 v[36:39], v[152:155], v[172:175], v[36:39]
    v_mfma_f32_16x16x32_bf16 v[40:43], v[152:155], v[176:179], v[40:43]
    v_mfma_f32_16x16x32_bf16 v[44:47], v[152:155], v[180:183], v[44:47]
    v_mfma_f32_16x16x32_bf16 v[48:51], v[156:159], v[168:171], v[48:51]
    v_mfma_f32_16x16x32_bf16 v[52:55], v[156:159], v[172:175], v[52:55]
    v_mfma_f32_16x16x32_bf16 v[56:59], v[156:159], v[176:179], v[56:59]
    v_mfma_f32_16x16x32_bf16 v[60:63], v[156:159], v[180:183], v[60:63]
    v_mfma_f32_16x16x32_bf16 v[64:67], v[160:163], v[168:171], v[64:67]
    v_mfma_f32_16x16x32_bf16 v[68:71], v[160:163], v[172:175], v[68:71]
    v_mfma_f32_16x16x32_bf16 v[72:75], v[160:163], v[176:179], v[72:75]
    v_mfma_f32_16x16x32_bf16 v[76:79], v[160:163], v[180:183], v[76:79]
    v_mfma_f32_16x16x32_bf16 v[80:83], v[164:167], v[168:171], v[80:83]
    v_mfma_f32_16x16x32_bf16 v[84:87], v[164:167], v[172:175], v[84:87]
    v_mfma_f32_16x16x32_bf16 v[88:91], v[164:167], v[176:179], v[88:91]
    v_mfma_f32_16x16x32_bf16 v[92:95], v[164:167], v[180:183], v[92:95]
    v_lshlrev_b32 v2, 4, v1
    s_add_u32 s30, s28, 1
    s_and_b32 s30, s30, 3
    s_mul_i32 s30, s30, 15360
    s_add_u32 s30, s30, 0
    v_add_u32 v3, s30, v2
    ds_write_b128 v3, v[20:23] offset:0
    ds_write_b128 v3, v[36:39] offset:1024
    ds_write_b128 v3, v[52:55] offset:2048
    ds_write_b128 v3, v[68:71] offset:3072
    ds_write_b128 v3, v[84:87] offset:4096
    s_add_u32 s30, s28, 2
    s_and_b32 s30, s30, 3
    s_mul_i32 s30, s30, 15360
    s_add_u32 s30, s30, 5120
    v_add_u32 v3, s30, v2
    ds_write_b128 v3, v[24:27] offset:0
    ds_write_b128 v3, v[40:43] offset:1024
    ds_write_b128 v3, v[56:59] offset:2048
    ds_write_b128 v3, v[72:75] offset:3072
    ds_write_b128 v3, v[88:91] offset:4096
    s_add_u32 s30, s28, 3
    s_and_b32 s30, s30, 3
    s_mul_i32 s30, s30, 15360
    s_add_u32 s30, s30, 10240
    v_add_u32 v3, s30, v2
    ds_write_b128 v3, v[28:31] offset:0
    ds_write_b128 v3, v[44:47] offset:1024
    ds_write_b128 v3, v[60:63] offset:2048
    ds_write_b128 v3, v[76:79] offset:3072
    ds_write_b128 v3, v[92:95] offset:4096
    s_mul_i32 s30, s28, 2560
    s_add_u32 s30, s30, 61440
    v_lshlrev_b32 v4, 4, v1
    v_add_u32 v4, s30, v4
    s_waitcnt vmcnt(0)
    ds_write_b128 v4, v[204:207]
    ds_write_b128 v4, v[208:211] offset:1024
    s_mov_b32 exec_hi, 0
    ds_write_b128 v4, v[212:215] offset:2048
    s_mov_b32 exec_hi, -1
    s_mul_i32 s31, s28, 15360
    s_add_u32 s31, s31, 0
    v_add_u32 v3, s31, v2
    v_lshrrev_b32 v5, 2, v1
    v_lshlrev_b32 v5, 5, v5
    v_and_b32 v6, 3, v1
    v_lshl_add_u32 v5, v6, 3, v5
    v_add_u32 v5, s30, v5
    s_waitcnt lgkmcnt(0)
    s_barrier
    ds_read_b128 v[96:99], v3 offset:0
    ds_read_b128 v[100:103], v3 offset:1024
    ds_read_b128 v[104:107], v3 offset:2048
    ds_read_b128 v[108:111], v3 offset:3072
    ds_read_b128 v[112:115], v3 offset:4096
    ds_read_b128 v[116:119], v3 offset:5120
    ds_read_b128 v[120:123], v3 offset:6144
    ds_read_b128 v[124:127], v3 offset:7168
    ds_read_b128 v[128:131], v3 offset:8192
    ds_read_b128 v[132:135], v3 offset:9216
    ds_read_b128 v[136:139], v3 offset:10240
    ds_read_b128 v[140:143], v3 offset:11264
    ds_read_b128 v[144:147], v3 offset:12288
    ds_read_b128 v[148:151], v3 offset:13312
    ds_read_b128 v[152:155], v3 offset:14336
    ds_read_b64_tr_b16 v[156:157], v5 offset:0
    ds_read_b64_tr_b16 v[158:159], v5 offset:512
    ds_read_b64_tr_b16 v[160:161], v5 offset:1024
    ds_read_b64_tr_b16 v[162:163], v5 offset:1536
    ds_read_b64_tr_b16 v[164:165], v5 offset:2048
    s_waitcnt lgkmcnt(5)
    v_pk_add_f32 v[16:17], v[16:17], v[96:97]
    v_pk_add_f32 v[16:17], v[16:17], v[116:117]
    v_pk_add_f32 v[16:17], v[16:17], v[136:137]
    v_pk_add_f32 v[18:19], v[18:19], v[98:99]
    v_pk_add_f32 v[18:19], v[18:19], v[118:119]
    v_pk_add_f32 v[18:19], v[18:19], v[138:139]
    v_pk_add_f32 v[32:33], v[32:33], v[100:101]
    v_pk_add_f32 v[32:33], v[32:33], v[120:121]
    v_pk_add_f32 v[32:33], v[32:33], v[140:141]
    v_pk_add_f32 v[34:35], v[34:35], v[102:103]
    v_pk_add_f32 v[34:35], v[34:35], v[122:123]
    v_pk_add_f32 v[34:35], v[34:35], v[142:143]
    v_pk_add_f32 v[48:49], v[48:49], v[104:105]
    v_pk_add_f32 v[48:49], v[48:49], v[124:125]
    v_pk_add_f32 v[48:49], v[48:49], v[144:145]
    v_pk_add_f32 v[50:51], v[50:51], v[106:107]
    v_pk_add_f32 v[50:51], v[50:51], v[126:127]
    v_pk_add_f32 v[50:51], v[50:51], v[146:147]
    v_pk_add_f32 v[64:65], v[64:65], v[108:109]
    v_pk_add_f32 v[64:65], v[64:65], v[128:129]
    v_pk_add_f32 v[64:65], v[64:65], v[148:149]
    v_pk_add_f32 v[66:67], v[66:67], v[110:111]
    v_pk_add_f32 v[66:67], v[66:67], v[130:131]
    v_pk_add_f32 v[66:67], v[66:67], v[150:151]
    v_pk_add_f32 v[80:81], v[80:81], v[112:113]
    v_pk_add_f32 v[80:81], v[80:81], v[132:133]
    v_pk_add_f32 v[80:81], v[80:81], v[152:153]
    v_pk_add_f32 v[82:83], v[82:83], v[114:115]
    v_pk_add_f32 v[82:83], v[82:83], v[134:135]
    v_pk_add_f32 v[82:83], v[82:83], v[154:155]
    v_mov_b32 v8, 0xbfb8aa3b
    v_mov_b32 v10, 1.0
    s_waitcnt lgkmcnt(0)
    v_lshlrev_b32 v96, 16, v194
    v_and_b32 v97, 0xffff0000, v194
    v_lshlrev_b32 v98, 16, v195
    v_and_b32 v99, 0xffff0000, v195
    v_pk_add_f32 v[16:17], v[16:17], v[96:97]
    v_pk_add_f32 v[18:19], v[18:19], v[98:99]
    v_pk_mul_f32 v[100:101], v[16:17], v[8:9] op_sel_hi:[1,0]
    v_pk_mul_f32 v[102:103], v[18:19], v[8:9] op_sel_hi:[1,0]
    v_exp_f32 v100, v100
    v_exp_f32 v101, v101
    v_exp_f32 v102, v102
    v_exp_f32 v103, v103
    v_pk_add_f32 v[100:101], v[100:101], v[10:11] op_sel_hi:[1,0]
    v_pk_add_f32 v[102:103], v[102:103], v[10:11] op_sel_hi:[1,0]
    v_rcp_f32 v100, v100
    v_rcp_f32 v101, v101
    v_rcp_f32 v102, v102
    v_rcp_f32 v103, v103
    v_pk_mul_f32 v[16:17], v[16:17], v[100:101]
    v_pk_mul_f32 v[18:19], v[18:19], v[102:103]
    v_lshlrev_b32 v96, 16, v156
    v_and_b32 v97, 0xffff0000, v156
    v_lshlrev_b32 v98, 16, v157
    v_and_b32 v99, 0xffff0000, v157
    v_lshlrev_b32 v104, 16, v184
    v_and_b32 v105, 0xffff0000, v184
    v_lshlrev_b32 v106, 16, v185
    v_and_b32 v107, 0xffff0000, v185
    v_pk_fma_f32 v[16:17], v[16:17], v[96:97], v[104:105]
    v_pk_fma_f32 v[18:19], v[18:19], v[98:99], v[106:107]
    v_cvt_pk_bf16_f32 v110, v16, v17
    v_cvt_pk_bf16_f32 v111, v18, v19
    buffer_store_dwordx2 v[110:111], v13, s[20:23], s36 offen offset:0
    v_lshlrev_b32 v96, 16, v196
    v_and_b32 v97, 0xffff0000, v196
    v_lshlrev_b32 v98, 16, v197
    v_and_b32 v99, 0xffff0000, v197
    v_pk_add_f32 v[32:33], v[32:33], v[96:97]
    v_pk_add_f32 v[34:35], v[34:35], v[98:99]
    v_pk_mul_f32 v[100:101], v[32:33], v[8:9] op_sel_hi:[1,0]
    v_pk_mul_f32 v[102:103], v[34:35], v[8:9] op_sel_hi:[1,0]
    v_exp_f32 v100, v100
    v_exp_f32 v101, v101
    v_exp_f32 v102, v102
    v_exp_f32 v103, v103
    v_pk_add_f32 v[100:101], v[100:101], v[10:11] op_sel_hi:[1,0]
    v_pk_add_f32 v[102:103], v[102:103], v[10:11] op_sel_hi:[1,0]
    v_rcp_f32 v100, v100
    v_rcp_f32 v101, v101
    v_rcp_f32 v102, v102
    v_rcp_f32 v103, v103
    v_pk_mul_f32 v[32:33], v[32:33], v[100:101]
    v_pk_mul_f32 v[34:35], v[34:35], v[102:103]
    v_lshlrev_b32 v96, 16, v158
    v_and_b32 v97, 0xffff0000, v158
    v_lshlrev_b32 v98, 16, v159
    v_and_b32 v99, 0xffff0000, v159
    v_lshlrev_b32 v104, 16, v186
    v_and_b32 v105, 0xffff0000, v186
    v_lshlrev_b32 v106, 16, v187
    v_and_b32 v107, 0xffff0000, v187
    v_pk_fma_f32 v[32:33], v[32:33], v[96:97], v[104:105]
    v_pk_fma_f32 v[34:35], v[34:35], v[98:99], v[106:107]
    v_cvt_pk_bf16_f32 v112, v32, v33
    v_cvt_pk_bf16_f32 v113, v34, v35
    buffer_store_dwordx2 v[112:113], v13, s[20:23], s36 offen offset:32
    v_lshlrev_b32 v96, 16, v198
    v_and_b32 v97, 0xffff0000, v198
    v_lshlrev_b32 v98, 16, v199
    v_and_b32 v99, 0xffff0000, v199
    v_pk_add_f32 v[48:49], v[48:49], v[96:97]
    v_pk_add_f32 v[50:51], v[50:51], v[98:99]
    v_pk_mul_f32 v[100:101], v[48:49], v[8:9] op_sel_hi:[1,0]
    v_pk_mul_f32 v[102:103], v[50:51], v[8:9] op_sel_hi:[1,0]
    v_exp_f32 v100, v100
    v_exp_f32 v101, v101
    v_exp_f32 v102, v102
    v_exp_f32 v103, v103
    v_pk_add_f32 v[100:101], v[100:101], v[10:11] op_sel_hi:[1,0]
    v_pk_add_f32 v[102:103], v[102:103], v[10:11] op_sel_hi:[1,0]
    v_rcp_f32 v100, v100
    v_rcp_f32 v101, v101
    v_rcp_f32 v102, v102
    v_rcp_f32 v103, v103
    v_pk_mul_f32 v[48:49], v[48:49], v[100:101]
    v_pk_mul_f32 v[50:51], v[50:51], v[102:103]
    v_lshlrev_b32 v96, 16, v160
    v_and_b32 v97, 0xffff0000, v160
    v_lshlrev_b32 v98, 16, v161
    v_and_b32 v99, 0xffff0000, v161
    v_lshlrev_b32 v104, 16, v188
    v_and_b32 v105, 0xffff0000, v188
    v_lshlrev_b32 v106, 16, v189
    v_and_b32 v107, 0xffff0000, v189
    v_pk_fma_f32 v[48:49], v[48:49], v[96:97], v[104:105]
    v_pk_fma_f32 v[50:51], v[50:51], v[98:99], v[106:107]
    v_cvt_pk_bf16_f32 v114, v48, v49
    v_cvt_pk_bf16_f32 v115, v50, v51
    buffer_store_dwordx2 v[114:115], v13, s[20:23], s36 offen offset:64
    v_lshlrev_b32 v96, 16, v200
    v_and_b32 v97, 0xffff0000, v200
    v_lshlrev_b32 v98, 16, v201
    v_and_b32 v99, 0xffff0000, v201
    v_pk_add_f32 v[64:65], v[64:65], v[96:97]
    v_pk_add_f32 v[66:67], v[66:67], v[98:99]
    v_pk_mul_f32 v[100:101], v[64:65], v[8:9] op_sel_hi:[1,0]
    v_pk_mul_f32 v[102:103], v[66:67], v[8:9] op_sel_hi:[1,0]
    v_exp_f32 v100, v100
    v_exp_f32 v101, v101
    v_exp_f32 v102, v102
    v_exp_f32 v103, v103
    v_pk_add_f32 v[100:101], v[100:101], v[10:11] op_sel_hi:[1,0]
    v_pk_add_f32 v[102:103], v[102:103], v[10:11] op_sel_hi:[1,0]
    v_rcp_f32 v100, v100
    v_rcp_f32 v101, v101
    v_rcp_f32 v102, v102
    v_rcp_f32 v103, v103
    v_pk_mul_f32 v[64:65], v[64:65], v[100:101]
    v_pk_mul_f32 v[66:67], v[66:67], v[102:103]
    v_lshlrev_b32 v96, 16, v162
    v_and_b32 v97, 0xffff0000, v162
    v_lshlrev_b32 v98, 16, v163
    v_and_b32 v99, 0xffff0000, v163
    v_lshlrev_b32 v104, 16, v190
    v_and_b32 v105, 0xffff0000, v190
    v_lshlrev_b32 v106, 16, v191
    v_and_b32 v107, 0xffff0000, v191
    v_pk_fma_f32 v[64:65], v[64:65], v[96:97], v[104:105]
    v_pk_fma_f32 v[66:67], v[66:67], v[98:99], v[106:107]
    v_cvt_pk_bf16_f32 v116, v64, v65
    v_cvt_pk_bf16_f32 v117, v66, v67
    buffer_store_dwordx2 v[116:117], v13, s[20:23], s36 offen offset:96
    v_lshlrev_b32 v96, 16, v202
    v_and_b32 v97, 0xffff0000, v202
    v_lshlrev_b32 v98, 16, v203
    v_and_b32 v99, 0xffff0000, v203
    v_pk_add_f32 v[80:81], v[80:81], v[96:97]
    v_pk_add_f32 v[82:83], v[82:83], v[98:99]
    v_pk_mul_f32 v[100:101], v[80:81], v[8:9] op_sel_hi:[1,0]
    v_pk_mul_f32 v[102:103], v[82:83], v[8:9] op_sel_hi:[1,0]
    v_exp_f32 v100, v100
    v_exp_f32 v101, v101
    v_exp_f32 v102, v102
    v_exp_f32 v103, v103
    v_pk_add_f32 v[100:101], v[100:101], v[10:11] op_sel_hi:[1,0]
    v_pk_add_f32 v[102:103], v[102:103], v[10:11] op_sel_hi:[1,0]
    v_rcp_f32 v100, v100
    v_rcp_f32 v101, v101
    v_rcp_f32 v102, v102
    v_rcp_f32 v103, v103
    v_pk_mul_f32 v[80:81], v[80:81], v[100:101]
    v_pk_mul_f32 v[82:83], v[82:83], v[102:103]
    v_lshlrev_b32 v96, 16, v164
    v_and_b32 v97, 0xffff0000, v164
    v_lshlrev_b32 v98, 16, v165
    v_and_b32 v99, 0xffff0000, v165
    v_lshlrev_b32 v104, 16, v192
    v_and_b32 v105, 0xffff0000, v192
    v_lshlrev_b32 v106, 16, v193
    v_and_b32 v107, 0xffff0000, v193
    v_pk_fma_f32 v[80:81], v[80:81], v[96:97], v[104:105]
    v_pk_fma_f32 v[82:83], v[82:83], v[98:99], v[106:107]
    v_cvt_pk_bf16_f32 v118, v80, v81
    v_cvt_pk_bf16_f32 v119, v82, v83
    buffer_store_dwordx2 v[118:119], v13, s[20:23], s36 offen offset:128
k_done:
k_exit:
    s_endpgm
.section .rodata,"a"
.p2align 6
.amdhsa_kernel recurrent_scan__ssm_conv_s4d__dense_activation_gelu__prompt_kernel
  .amdhsa_next_free_vgpr 256
  .amdhsa_next_free_sgpr 100
  .amdhsa_accum_offset 256
  .amdhsa_group_segment_fixed_size 0
  .amdhsa_kernarg_size 120
  .amdhsa_user_sgpr_count 2
  .amdhsa_user_sgpr_kernarg_segment_ptr 1
  .amdhsa_system_sgpr_workgroup_id_x 1
  .amdhsa_float_denorm_mode_32 3
.end_amdhsa_kernel
```
